```python
import torch

def _softmax(x, axis=-1):
    return torch.softmax(x, dim=axis)
def _gelu(x):
    return torch.nn.functional.gelu(x, approximate="tanh")
def _silu(x):
    return torch.nn.functional.silu(x)
def _sigmoid(x):
    return torch.sigmoid(x)
def _layernorm(x, axis=-1, eps=1e-5):
    m = x.mean(dim=axis, keepdim=True)
    v = x.var(dim=axis, keepdim=True, unbiased=False)
    return (x - m) / torch.sqrt(v + eps)
def _scatter_add(tgt, idx, src, axis=0):
    return tgt.clone().index_add_(axis, idx, src)
def _segment_sum(src, seg, n):
    out = torch.zeros((n,) + src.shape[1:], dtype=src.dtype)
    return out.index_add_(0, seg, src)
def _pad(x, pw):
    flat = tuple(v for pair in reversed(pw) for v in pair)
    return torch.nn.functional.pad(x, flat)

kernel_name = 'standalone__gqa_block_cached__near_ridge'

def setup_inputs():

    _w = (lambda a: (lambda t: t.to(torch.bfloat16) if t.is_floating_point() else t)(torch.as_tensor(a)))
    B, Sq, D = 8, 48, 512
    Hq, Hkv, Sk, Dh = 32, 8, 2048, 128
    assert Hq % Hkv == 0, (Hq, Hkv)
    return {
        "x": _w((lambda *s: torch.randn(*s, dtype=torch.bfloat16) * 0.8)(B, Sq, D)),
        "k_cache": _w((lambda *s: torch.randn(*s, dtype=torch.bfloat16) * 0.8)(B, Hkv, Sk, Dh)),
        "v_cache": _w((lambda *s: torch.randn(*s, dtype=torch.bfloat16) * 0.05)(B, Hkv, Sk, Dh)),
        "wq": _w((lambda *s: torch.randn(*s, dtype=torch.bfloat16) * 0.8)(D, Hq * Dh) * (D ** -0.5)),
        "wo": _w((lambda *s: torch.randn(*s, dtype=torch.bfloat16) * 0.05)(Hq * Dh, D) * ((Hq * Dh) ** -0.5)),
    }

def reference(x, k_cache, v_cache, wq, wo):
    B, Sq, D = x.shape
    Hq, Dh = 32, 128
    Hkv = k_cache.shape[1]
    rep = Hq // Hkv
    q = (lambda x, *d: x.permute(*d))((x @ wq).reshape(B, Sq, Hq, Dh), 0, 2, 1, 3)
    k = (lambda x, n, axis: torch.repeat_interleave(x, n, dim=axis))(k_cache, rep, axis=1)
    v = (lambda x, n, axis: torch.repeat_interleave(x, n, dim=axis))(v_cache, rep, axis=1)
    scores = torch.einsum("bhqd,bhkd->bhqk", q, k) * (Dh ** -0.5)
    p = _softmax(scores, axis=-1)
    o = torch.einsum("bhqk,bhkd->bhqd", p, v)
    return (lambda x, *d: x.permute(*d))(o, 0, 2, 1, 3).reshape(B, Sq, Hq * Dh) @ wo
```

```asm
; @launch grid=(256,1,1) block=(512,1,1) lds=163840
.amdgcn_target "amdgcn-amd-amdhsa--gfx950"
.text
.globl standalone__gqa_block_cached__near_ridge_kernel
.p2align 8
.type standalone__gqa_block_cached__near_ridge_kernel,@function
standalone__gqa_block_cached__near_ridge_kernel:
  s_cmp_ge_u32 s2, 256
  s_cbranch_scc1 L_end
  s_load_dwordx16 s[40:55], s[0:1], 0
  s_memrealtime s[64:65]
  v_lshrrev_b32 v17, 6, v0
  v_and_b32 v1, 63, v0
  v_readfirstlane_b32 s56, v17
  v_and_b32 v2, 15, v0
  v_bfe_u32 v3, v0, 4, 2
  v_lshlrev_b32 v0, 4, v1
  s_cmp_lg_u32 s56, 7
  s_cbranch_scc1 L_pfc_skip
  s_getpc_b64 s[84:85]
  v_lshlrev_b32 v17, 7, v1
  global_load_dword v31, v17, s[84:85]
  v_add_u32 v17, 0x2000, v17
  global_load_dword v31, v17, s[84:85]
  v_add_u32 v17, 0x2000, v17
  global_load_dword v31, v17, s[84:85]
  v_add_u32 v17, 0x2000, v17
  global_load_dword v31, v17, s[84:85]
  v_add_u32 v17, 0x2000, v17
  global_load_dword v31, v17, s[84:85]
  v_add_u32 v17, 0x2000, v17
L_pfc_skip:
  s_and_b32 s59, s2, 7
  s_lshr_b32 s60, s2, 5
  s_bfe_u32 s61, s2, 0x20003
  s_and_b32 s57, s56, 3
  s_lshr_b32 s58, s56, 2
  s_lshl_b32 s63, s56, 10
  s_lshr_b32 s68, s57, 1
  s_xor_b32 s69, s57, s68
  s_and_b32 s69, s69, 1
  s_lshl_b32 s69, s69, 1
  s_or_b32 s69, s69, s68
  v_and_b32 v19, 3, v1
  v_xor_b32 v17, s69, v19
  v_lshlrev_b32 v17, 4, v17
  v_lshl_add_u32 v17, v3, 6, v17
  v_bfe_u32 v18, v1, 2, 2
  v_lshl_add_u32 v7, v18, 8, v17
  v_lshl_add_u32 v16, v18, 10, v17
  s_lshl_b32 s68, s57, 12
  v_add_u32 v16, s68, v16
  v_lshl_add_u32 v18, v3, 3, v18
  v_and_b32 v17, 1, v3
  v_lshlrev_b32 v17, 1, v17
  v_xor_b32 v17, v17, v19
  v_lshlrev_b32 v17, 4, v17
  v_lshl_add_u32 v15, v18, 13, v17
  s_lshl_b32 s70, s59, 1
  s_lshr_b32 s68, s61, 1
  s_add_u32 s70, s70, s68
  s_lshl_b32 s70, s70, 3
  s_add_u32 s70, s70, s56
  s_lshl_b32 s70, s70, 6
  s_mul_i32 s71, s60, 49152
  s_waitcnt lgkmcnt(0)
  s_mov_b32 s4, s40
  s_and_b32 s5, s41, 0xffff
  s_mov_b32 s6, 0x60000
  s_mov_b32 s7, 0x20000
  s_mov_b32 s16, s46
  s_and_b32 s17, s47, 0xffff
  s_mov_b32 s18, 0x400000
  s_mov_b32 s19, 0x20000
  s_mul_i32 s88, s61, 3
  s_lshr_b32 s88, s88, 1
  s_mov_b32 s86, 0
L_xl:
  s_lshl_b32 s66, s88, 1
  s_add_u32 s66, s66, s58
  s_mul_i32 s67, s66, 11
  s_lshr_b32 s67, s67, 5
  s_mul_i32 s68, s67, 3
  s_sub_u32 s68, s66, s68
  s_lshl_b32 s68, s68, 14
  s_lshl_b32 s67, s67, 8
  s_add_u32 s68, s68, s67
  s_lshl_b32 s69, s88, 13
  s_add_u32 s69, s69, s63
  s_add_u32 m0, s69, 106496
  s_add_u32 s68, s68, s71
  buffer_load_dwordx4 v16, s[4:7], s68 offen  lds
  s_add_u32 s88, s88, 1
  s_cmp_eq_u32 s88, 6
  s_cselect_b32 s88, 0, s88
  s_add_u32 s86, s86, 1
  s_cmp_lt_u32 s86, 6
  s_cbranch_scc1 L_xl
  s_lshl_b32 s89, s56, 13
  s_lshl_b32 s90, s60, 1
  s_and_b32 s66, s61, 1
  s_add_u32 s90, s90, s66
  s_add_u32 s66, s90, 0
  s_and_b32 s66, s66, 15
  s_lshl_b32 s66, s66, 18
  s_add_u32 m0, s63, 0
  s_add_u32 s66, s66, s70
  buffer_load_dwordx4 v15, s[16:19], s66 offen  lds
  s_add_u32 m0, s63, 8192
  s_add_u32 s66, s66, 0x8000
  buffer_load_dwordx4 v15, s[16:19], s66 offen  lds
  s_add_u32 s66, s90, 1
  s_and_b32 s66, s66, 15
  s_lshl_b32 s66, s66, 18
  s_add_u32 m0, s63, 16384
  s_add_u32 s66, s66, s70
  buffer_load_dwordx4 v15, s[16:19], s66 offen  lds
  s_add_u32 m0, s63, 24576
  s_add_u32 s66, s66, 0x8000
  buffer_load_dwordx4 v15, s[16:19], s66 offen  lds
  s_mov_b32 s32, s54
  s_and_b32 s33, s55, 0xffff
  s_mov_b32 s34, 0x10000000
  s_mov_b32 s35, 0x20000
  s_mov_b32 s28, s52
  s_and_b32 s29, s53, 0xffff
  s_mov_b32 s30, 0x100
  s_mov_b32 s31, 0x20000
  s_mov_b32 s8, s42
  s_and_b32 s9, s43, 0xffff
  s_mov_b32 s10, 0x2000000
  s_mov_b32 s11, 0x20000
  s_mov_b32 s12, s44
  s_and_b32 s13, s45, 0xffff
  s_mov_b32 s14, 0x2000000
  s_mov_b32 s15, 0x20000
  s_mov_b32 s20, s48
  s_and_b32 s21, s49, 0xffff
  s_mov_b32 s22, 0x400000
  s_mov_b32 s23, 0x20000
  s_mov_b32 s24, s50
  s_and_b32 s25, s51, 0xffff
  s_mov_b32 s26, 0x60000
  s_mov_b32 s27, 0x20000
  v_add_u32 v7, s63, v7
  v_bfe_u32 v18, v1, 2, 3
  v_and_b32 v19, 1, v3
  v_lshlrev_b32 v19, 1, v19
  v_and_b32 v17, 3, v1
  v_xor_b32 v17, v17, v19
  v_lshlrev_b32 v17, 4, v17
  v_lshrrev_b32 v19, 5, v1
  v_lshl_add_u32 v17, v19, 6, v17
  s_and_b32 s68, s56, 1
  s_lshl_b32 s68, s68, 7
  v_add_u32 v17, s68, v17
  s_lshr_b32 s68, s56, 1
  s_lshl_b32 s69, s68, 3
  v_add_u32 v19, s69, v18
  v_lshl_add_u32 v8, v19, 8, v17
  v_lshl_add_u32 v20, v19, 10, v17
  s_lshl_b32 s62, s60, 3
  s_add_u32 s62, s62, s59
  s_lshl_b32 s62, s62, 19
  s_and_b32 s68, s61, 1
  s_lshl_b32 s68, s68, 18
  s_add_u32 s62, s62, s68
  v_lshrrev_b32 v17, 2, v2
  v_lshrrev_b32 v18, 1, v17
  v_xor_b32 v19, v17, v18
  v_and_b32 v19, 1, v19
  v_lshl_or_b32 v18, v19, 1, v18
  v_xor_b32 v18, v18, v3
  v_lshlrev_b32 v17, 10, v17
  v_lshl_add_u32 v17, v18, 4, v17
  v_and_b32 v18, 3, v2
  v_lshl_add_u32 v4, v18, 6, v17
  v_lshrrev_b32 v17, 5, v1
  v_lshlrev_b32 v17, 11, v17
  v_bfe_u32 v18, v1, 2, 3
  v_lshl_add_u32 v17, v18, 6, v17
  v_and_b32 v18, 1, v3
  v_lshl_add_u32 v17, v18, 5, v17
  v_and_b32 v18, 3, v1
  v_lshl_add_u32 v5, v18, 3, v17
  v_xor_b32 v6, 32, v5
  s_mov_b32 s72, 0x43800000
  s_mov_b32 s87, 0x3e0293ee
  s_lshl_b32 s73, s59, 19
  s_lshl_b32 s68, s61, 8
  s_add_u32 s73, s73, s68
  s_getreg_b32 s98, hwreg(HW_REG_XCC_ID)
  s_and_b32 s98, s98, 15
  s_bitcmp1_b32 s61, 1
  s_cselect_b32 s36, s12, s8
  s_cselect_b32 s37, s13, s9
  s_mov_b32 s38, 0x2000000
  s_mov_b32 s39, 0x20000
  s_lshl_b32 s75, s56, 13
  s_add_u32 s75, s75, s62
  s_getpc_b64 s[96:97]
L_pc0:
  s_add_u32 s78, s96, L_rescale0-L_pc0
  s_addc_u32 s79, s97, 0
  s_add_u32 s80, s96, L_rescale1-L_pc0
  s_addc_u32 s81, s97, 0
  s_add_u32 s82, s96, L_rescale2-L_pc0
  s_addc_u32 s83, s97, 0
  s_lshl_b32 s68, s60, 3
  v_mov_b32 v28, s68
  s_and_b32 s68, s2, 31
  s_lshl_b32 s68, s68, 3
  s_add_u32 s68, s68, s56
  s_cmp_lg_u32 s68, 4
  s_cbranch_scc1 L_nonce_skip
  s_or_b32 s68, s64, 1
  v_mov_b32 v24, s68
  v_mov_b32 v25, s65
  s_mov_b64 exec, 1
  buffer_store_dwordx2 v[24:25], v28, s[28:31], 0 offen sc1
  s_mov_b64 exec, -1
L_nonce_skip:
  v_lshrrev_b32 v17, 2, v1
  v_lshlrev_b32 v17, 6, v17
  v_and_b32 v18, 1, v3
  v_lshl_add_u32 v17, v18, 5, v17
  v_and_b32 v18, 3, v1
  v_lshl_add_u32 v17, v18, 3, v17
  v_add_u32 v12, s63, v17
  v_xor_b32 v13, 32, v12
  v_add_u32 v14, 106496, v4
  s_waitcnt vmcnt(4)
  s_barrier
  s_add_u32 s66, s90, 2
  s_and_b32 s66, s66, 15
  s_lshl_b32 s66, s66, 18
  s_add_u32 m0, s63, 32768
  s_add_u32 s66, s66, s70
  buffer_load_dwordx4 v15, s[16:19], s66 offen  lds
  s_add_u32 m0, s63, 40960
  s_add_u32 s66, s66, 0x8000
  buffer_load_dwordx4 v15, s[16:19], s66 offen  lds
  s_add_u32 s66, s90, 3
  s_and_b32 s66, s66, 15
  s_lshl_b32 s66, s66, 18
  s_add_u32 m0, s63, 49152
  s_add_u32 s66, s66, s70
  buffer_load_dwordx4 v15, s[16:19], s66 offen  lds
  s_add_u32 m0, s63, 57344
  s_add_u32 s66, s66, 0x8000
  buffer_load_dwordx4 v15, s[16:19], s66 offen  lds
  s_waitcnt vmcnt(6)
  s_add_u32 s66, s90, 0
  s_bfe_u32 s67, s66, 0x20002
  s_mul_i32 s67, s67, 12288
  s_and_b32 s66, s66, 3
  s_lshl_b32 s66, s66, 8
  s_add_u32 s66, s66, s67
  v_add_u32 v17, s66, v14
  ds_read_b64_tr_b16 v[64:65], v12 offset:0
  ds_read_b64_tr_b16 v[66:67], v12 offset:8192
  ds_read_b64_tr_b16 v[68:69], v13 offset:0
  ds_read_b64_tr_b16 v[70:71], v13 offset:8192
  ds_read_b128 v[72:75], v17 offset:0
  ds_read_b128 v[76:79], v17 offset:4096
  ds_read_b128 v[80:83], v17 offset:8192
  s_waitcnt vmcnt(4)
  s_add_u32 s66, s90, 1
  s_bfe_u32 s67, s66, 0x20002
  s_mul_i32 s67, s67, 12288
  s_and_b32 s66, s66, 3
  s_lshl_b32 s66, s66, 8
  s_add_u32 s66, s66, s67
  v_add_u32 v17, s66, v14
  ds_read_b64_tr_b16 v[84:85], v12 offset:16384
  ds_read_b64_tr_b16 v[86:87], v12 offset:24576
  ds_read_b64_tr_b16 v[88:89], v13 offset:16384
  ds_read_b64_tr_b16 v[90:91], v13 offset:24576
  ds_read_b128 v[92:95], v17 offset:0
  ds_read_b128 v[96:99], v17 offset:4096
  ds_read_b128 v[100:103], v17 offset:8192
  s_waitcnt lgkmcnt(7)
  s_add_u32 s66, s90, 4
  s_and_b32 s66, s66, 15
  s_lshl_b32 s66, s66, 18
  s_add_u32 m0, s63, 0
  s_add_u32 s66, s66, s70
  buffer_load_dwordx4 v15, s[16:19], s66 offen  lds
  s_add_u32 m0, s63, 8192
  s_add_u32 s66, s66, 0x8000
  buffer_load_dwordx4 v15, s[16:19], s66 offen  lds
  v_mfma_f32_16x16x32_bf16 v[32:35], v[64:67], v[72:75], 0
  v_mfma_f32_16x16x32_bf16 v[36:39], v[64:67], v[76:79], 0
  v_mfma_f32_16x16x32_bf16 v[40:43], v[64:67], v[80:83], 0
  v_mfma_f32_16x16x32_bf16 v[44:47], v[68:71], v[72:75], 0
  v_mfma_f32_16x16x32_bf16 v[48:51], v[68:71], v[76:79], 0
  v_mfma_f32_16x16x32_bf16 v[52:55], v[68:71], v[80:83], 0
  s_waitcnt vmcnt(4)
  s_add_u32 s66, s90, 2
  s_bfe_u32 s67, s66, 0x20002
  s_mul_i32 s67, s67, 12288
  s_and_b32 s66, s66, 3
  s_lshl_b32 s66, s66, 8
  s_add_u32 s66, s66, s67
  v_add_u32 v17, s66, v14
  ds_read_b64_tr_b16 v[104:105], v12 offset:32768
  ds_read_b64_tr_b16 v[106:107], v12 offset:40960
  ds_read_b64_tr_b16 v[108:109], v13 offset:32768
  ds_read_b64_tr_b16 v[110:111], v13 offset:40960
  ds_read_b128 v[112:115], v17 offset:0
  ds_read_b128 v[116:119], v17 offset:4096
  ds_read_b128 v[120:123], v17 offset:8192
  s_waitcnt lgkmcnt(7)
  s_add_u32 s66, s90, 5
  s_and_b32 s66, s66, 15
  s_lshl_b32 s66, s66, 18
  s_add_u32 m0, s63, 16384
  s_add_u32 s66, s66, s70
  buffer_load_dwordx4 v15, s[16:19], s66 offen  lds
  s_add_u32 m0, s63, 24576
  s_add_u32 s66, s66, 0x8000
  buffer_load_dwordx4 v15, s[16:19], s66 offen  lds
  v_mfma_f32_16x16x32_bf16 v[32:35], v[84:87], v[92:95], v[32:35]
  v_mfma_f32_16x16x32_bf16 v[36:39], v[84:87], v[96:99], v[36:39]
  v_mfma_f32_16x16x32_bf16 v[40:43], v[84:87], v[100:103], v[40:43]
  v_mfma_f32_16x16x32_bf16 v[44:47], v[88:91], v[92:95], v[44:47]
  v_mfma_f32_16x16x32_bf16 v[48:51], v[88:91], v[96:99], v[48:51]
  v_mfma_f32_16x16x32_bf16 v[52:55], v[88:91], v[100:103], v[52:55]
  s_waitcnt vmcnt(4)
  s_add_u32 s66, s90, 3
  s_bfe_u32 s67, s66, 0x20002
  s_mul_i32 s67, s67, 12288
  s_and_b32 s66, s66, 3
  s_lshl_b32 s66, s66, 8
  s_add_u32 s66, s66, s67
  v_add_u32 v17, s66, v14
  ds_read_b64_tr_b16 v[64:65], v12 offset:49152
  ds_read_b64_tr_b16 v[66:67], v12 offset:57344
  ds_read_b64_tr_b16 v[68:69], v13 offset:49152
  ds_read_b64_tr_b16 v[70:71], v13 offset:57344
  ds_read_b128 v[72:75], v17 offset:0
  ds_read_b128 v[76:79], v17 offset:4096
  ds_read_b128 v[80:83], v17 offset:8192
  s_waitcnt lgkmcnt(7)
  s_add_u32 s66, s90, 6
  s_and_b32 s66, s66, 15
  s_lshl_b32 s66, s66, 18
  s_add_u32 m0, s63, 32768
  s_add_u32 s66, s66, s70
  buffer_load_dwordx4 v15, s[16:19], s66 offen  lds
  s_add_u32 m0, s63, 40960
  s_add_u32 s66, s66, 0x8000
  buffer_load_dwordx4 v15, s[16:19], s66 offen  lds
  v_mfma_f32_16x16x32_bf16 v[32:35], v[104:107], v[112:115], v[32:35]
  v_mfma_f32_16x16x32_bf16 v[36:39], v[104:107], v[116:119], v[36:39]
  v_mfma_f32_16x16x32_bf16 v[40:43], v[104:107], v[120:123], v[40:43]
  v_mfma_f32_16x16x32_bf16 v[44:47], v[108:111], v[112:115], v[44:47]
  v_mfma_f32_16x16x32_bf16 v[48:51], v[108:111], v[116:119], v[48:51]
  v_mfma_f32_16x16x32_bf16 v[52:55], v[108:111], v[120:123], v[52:55]
  s_waitcnt vmcnt(4)
  s_add_u32 s66, s90, 4
  s_bfe_u32 s67, s66, 0x20002
  s_mul_i32 s67, s67, 12288
  s_and_b32 s66, s66, 3
  s_lshl_b32 s66, s66, 8
  s_add_u32 s66, s66, s67
  v_add_u32 v17, s66, v14
  ds_read_b64_tr_b16 v[84:85], v12 offset:0
  ds_read_b64_tr_b16 v[86:87], v12 offset:8192
  ds_read_b64_tr_b16 v[88:89], v13 offset:0
  ds_read_b64_tr_b16 v[90:91], v13 offset:8192
  ds_read_b128 v[92:95], v17 offset:0
  ds_read_b128 v[96:99], v17 offset:4096
  ds_read_b128 v[100:103], v17 offset:8192
  s_waitcnt lgkmcnt(7)
  s_add_u32 s66, s90, 7
  s_and_b32 s66, s66, 15
  s_lshl_b32 s66, s66, 18
  s_add_u32 m0, s63, 49152
  s_add_u32 s66, s66, s70
  buffer_load_dwordx4 v15, s[16:19], s66 offen  lds
  s_add_u32 m0, s63, 57344
  s_add_u32 s66, s66, 0x8000
  buffer_load_dwordx4 v15, s[16:19], s66 offen  lds
  v_mfma_f32_16x16x32_bf16 v[32:35], v[64:67], v[72:75], v[32:35]
  v_mfma_f32_16x16x32_bf16 v[36:39], v[64:67], v[76:79], v[36:39]
  v_mfma_f32_16x16x32_bf16 v[40:43], v[64:67], v[80:83], v[40:43]
  v_mfma_f32_16x16x32_bf16 v[44:47], v[68:71], v[72:75], v[44:47]
  v_mfma_f32_16x16x32_bf16 v[48:51], v[68:71], v[76:79], v[48:51]
  v_mfma_f32_16x16x32_bf16 v[52:55], v[68:71], v[80:83], v[52:55]
  s_waitcnt vmcnt(4)
  s_add_u32 s66, s90, 5
  s_bfe_u32 s67, s66, 0x20002
  s_mul_i32 s67, s67, 12288
  s_and_b32 s66, s66, 3
  s_lshl_b32 s66, s66, 8
  s_add_u32 s66, s66, s67
  v_add_u32 v17, s66, v14
  ds_read_b64_tr_b16 v[104:105], v12 offset:16384
  ds_read_b64_tr_b16 v[106:107], v12 offset:24576
  ds_read_b64_tr_b16 v[108:109], v13 offset:16384
  ds_read_b64_tr_b16 v[110:111], v13 offset:24576
  ds_read_b128 v[112:115], v17 offset:0
  ds_read_b128 v[116:119], v17 offset:4096
  ds_read_b128 v[120:123], v17 offset:8192
  s_waitcnt lgkmcnt(7)
  s_add_u32 s66, s90, 8
  s_and_b32 s66, s66, 15
  s_lshl_b32 s66, s66, 18
  s_add_u32 m0, s63, 0
  s_add_u32 s66, s66, s70
  buffer_load_dwordx4 v15, s[16:19], s66 offen  lds
  s_add_u32 m0, s63, 8192
  s_add_u32 s66, s66, 0x8000
  buffer_load_dwordx4 v15, s[16:19], s66 offen  lds
  v_mfma_f32_16x16x32_bf16 v[32:35], v[84:87], v[92:95], v[32:35]
  v_mfma_f32_16x16x32_bf16 v[36:39], v[84:87], v[96:99], v[36:39]
  v_mfma_f32_16x16x32_bf16 v[40:43], v[84:87], v[100:103], v[40:43]
  v_mfma_f32_16x16x32_bf16 v[44:47], v[88:91], v[92:95], v[44:47]
  v_mfma_f32_16x16x32_bf16 v[48:51], v[88:91], v[96:99], v[48:51]
  v_mfma_f32_16x16x32_bf16 v[52:55], v[88:91], v[100:103], v[52:55]
  s_waitcnt vmcnt(4)
  s_add_u32 s66, s90, 6
  s_bfe_u32 s67, s66, 0x20002
  s_mul_i32 s67, s67, 12288
  s_and_b32 s66, s66, 3
  s_lshl_b32 s66, s66, 8
  s_add_u32 s66, s66, s67
  v_add_u32 v17, s66, v14
  ds_read_b64_tr_b16 v[64:65], v12 offset:32768
  ds_read_b64_tr_b16 v[66:67], v12 offset:40960
  ds_read_b64_tr_b16 v[68:69], v13 offset:32768
  ds_read_b64_tr_b16 v[70:71], v13 offset:40960
  ds_read_b128 v[72:75], v17 offset:0
  ds_read_b128 v[76:79], v17 offset:4096
  ds_read_b128 v[80:83], v17 offset:8192
  s_waitcnt lgkmcnt(7)
  s_add_u32 s66, s90, 9
  s_and_b32 s66, s66, 15
  s_lshl_b32 s66, s66, 18
  s_add_u32 m0, s63, 16384
  s_add_u32 s66, s66, s70
  buffer_load_dwordx4 v15, s[16:19], s66 offen  lds
  s_add_u32 m0, s63, 24576
  s_add_u32 s66, s66, 0x8000
  buffer_load_dwordx4 v15, s[16:19], s66 offen  lds
  v_mfma_f32_16x16x32_bf16 v[32:35], v[104:107], v[112:115], v[32:35]
  v_mfma_f32_16x16x32_bf16 v[36:39], v[104:107], v[116:119], v[36:39]
  v_mfma_f32_16x16x32_bf16 v[40:43], v[104:107], v[120:123], v[40:43]
  v_mfma_f32_16x16x32_bf16 v[44:47], v[108:111], v[112:115], v[44:47]
  v_mfma_f32_16x16x32_bf16 v[48:51], v[108:111], v[116:119], v[48:51]
  v_mfma_f32_16x16x32_bf16 v[52:55], v[108:111], v[120:123], v[52:55]
  s_waitcnt vmcnt(4)
  s_add_u32 s66, s90, 7
  s_bfe_u32 s67, s66, 0x20002
  s_mul_i32 s67, s67, 12288
  s_and_b32 s66, s66, 3
  s_lshl_b32 s66, s66, 8
  s_add_u32 s66, s66, s67
  v_add_u32 v17, s66, v14
  ds_read_b64_tr_b16 v[84:85], v12 offset:49152
  ds_read_b64_tr_b16 v[86:87], v12 offset:57344
  ds_read_b64_tr_b16 v[88:89], v13 offset:49152
  ds_read_b64_tr_b16 v[90:91], v13 offset:57344
  ds_read_b128 v[92:95], v17 offset:0
  ds_read_b128 v[96:99], v17 offset:4096
  ds_read_b128 v[100:103], v17 offset:8192
  s_waitcnt lgkmcnt(7)
  s_add_u32 s66, s90, 10
  s_and_b32 s66, s66, 15
  s_lshl_b32 s66, s66, 18
  s_add_u32 m0, s63, 32768
  s_add_u32 s66, s66, s70
  buffer_load_dwordx4 v15, s[16:19], s66 offen  lds
  s_add_u32 m0, s63, 40960
  s_add_u32 s66, s66, 0x8000
  buffer_load_dwordx4 v15, s[16:19], s66 offen  lds
  v_mfma_f32_16x16x32_bf16 v[32:35], v[64:67], v[72:75], v[32:35]
  v_mfma_f32_16x16x32_bf16 v[36:39], v[64:67], v[76:79], v[36:39]
  v_mfma_f32_16x16x32_bf16 v[40:43], v[64:67], v[80:83], v[40:43]
  v_mfma_f32_16x16x32_bf16 v[44:47], v[68:71], v[72:75], v[44:47]
  v_mfma_f32_16x16x32_bf16 v[48:51], v[68:71], v[76:79], v[48:51]
  v_mfma_f32_16x16x32_bf16 v[52:55], v[68:71], v[80:83], v[52:55]
  s_waitcnt vmcnt(4)
  s_add_u32 s66, s90, 8
  s_bfe_u32 s67, s66, 0x20002
  s_mul_i32 s67, s67, 12288
  s_and_b32 s66, s66, 3
  s_lshl_b32 s66, s66, 8
  s_add_u32 s66, s66, s67
  v_add_u32 v17, s66, v14
  ds_read_b64_tr_b16 v[104:105], v12 offset:0
  ds_read_b64_tr_b16 v[106:107], v12 offset:8192
  ds_read_b64_tr_b16 v[108:109], v13 offset:0
  ds_read_b64_tr_b16 v[110:111], v13 offset:8192
  ds_read_b128 v[112:115], v17 offset:0
  ds_read_b128 v[116:119], v17 offset:4096
  ds_read_b128 v[120:123], v17 offset:8192
  s_waitcnt lgkmcnt(7)
  s_add_u32 s66, s90, 11
  s_and_b32 s66, s66, 15
  s_lshl_b32 s66, s66, 18
  s_add_u32 m0, s63, 49152
  s_add_u32 s66, s66, s70
  buffer_load_dwordx4 v15, s[16:19], s66 offen  lds
  s_add_u32 m0, s63, 57344
  s_add_u32 s66, s66, 0x8000
  buffer_load_dwordx4 v15, s[16:19], s66 offen  lds
  v_mfma_f32_16x16x32_bf16 v[32:35], v[84:87], v[92:95], v[32:35]
  v_mfma_f32_16x16x32_bf16 v[36:39], v[84:87], v[96:99], v[36:39]
  v_mfma_f32_16x16x32_bf16 v[40:43], v[84:87], v[100:103], v[40:43]
  v_mfma_f32_16x16x32_bf16 v[44:47], v[88:91], v[92:95], v[44:47]
  v_mfma_f32_16x16x32_bf16 v[48:51], v[88:91], v[96:99], v[48:51]
  v_mfma_f32_16x16x32_bf16 v[52:55], v[88:91], v[100:103], v[52:55]
  s_waitcnt vmcnt(4)
  s_add_u32 s66, s90, 9
  s_bfe_u32 s67, s66, 0x20002
  s_mul_i32 s67, s67, 12288
  s_and_b32 s66, s66, 3
  s_lshl_b32 s66, s66, 8
  s_add_u32 s66, s66, s67
  v_add_u32 v17, s66, v14
  ds_read_b64_tr_b16 v[64:65], v12 offset:16384
  ds_read_b64_tr_b16 v[66:67], v12 offset:24576
  ds_read_b64_tr_b16 v[68:69], v13 offset:16384
  ds_read_b64_tr_b16 v[70:71], v13 offset:24576
  ds_read_b128 v[72:75], v17 offset:0
  ds_read_b128 v[76:79], v17 offset:4096
  ds_read_b128 v[80:83], v17 offset:8192
  s_waitcnt lgkmcnt(7)
  s_add_u32 s66, s90, 12
  s_and_b32 s66, s66, 15
  s_lshl_b32 s66, s66, 18
  s_add_u32 m0, s63, 0
  s_add_u32 s66, s66, s70
  buffer_load_dwordx4 v15, s[16:19], s66 offen  lds
  s_add_u32 m0, s63, 8192
  s_add_u32 s66, s66, 0x8000
  buffer_load_dwordx4 v15, s[16:19], s66 offen  lds
  v_mfma_f32_16x16x32_bf16 v[32:35], v[104:107], v[112:115], v[32:35]
  v_mfma_f32_16x16x32_bf16 v[36:39], v[104:107], v[116:119], v[36:39]
  v_mfma_f32_16x16x32_bf16 v[40:43], v[104:107], v[120:123], v[40:43]
  v_mfma_f32_16x16x32_bf16 v[44:47], v[108:111], v[112:115], v[44:47]
  v_mfma_f32_16x16x32_bf16 v[48:51], v[108:111], v[116:119], v[48:51]
  v_mfma_f32_16x16x32_bf16 v[52:55], v[108:111], v[120:123], v[52:55]
  s_waitcnt vmcnt(4)
  s_add_u32 s66, s90, 10
  s_bfe_u32 s67, s66, 0x20002
  s_mul_i32 s67, s67, 12288
  s_and_b32 s66, s66, 3
  s_lshl_b32 s66, s66, 8
  s_add_u32 s66, s66, s67
  v_add_u32 v17, s66, v14
  ds_read_b64_tr_b16 v[84:85], v12 offset:32768
  ds_read_b64_tr_b16 v[86:87], v12 offset:40960
  ds_read_b64_tr_b16 v[88:89], v13 offset:32768
  ds_read_b64_tr_b16 v[90:91], v13 offset:40960
  ds_read_b128 v[92:95], v17 offset:0
  ds_read_b128 v[96:99], v17 offset:4096
  ds_read_b128 v[100:103], v17 offset:8192
  s_waitcnt lgkmcnt(7)
  s_add_u32 s66, s90, 13
  s_and_b32 s66, s66, 15
  s_lshl_b32 s66, s66, 18
  s_add_u32 m0, s63, 16384
  s_add_u32 s66, s66, s70
  buffer_load_dwordx4 v15, s[16:19], s66 offen  lds
  s_add_u32 m0, s63, 24576
  s_add_u32 s66, s66, 0x8000
  buffer_load_dwordx4 v15, s[16:19], s66 offen  lds
  v_mfma_f32_16x16x32_bf16 v[32:35], v[64:67], v[72:75], v[32:35]
  v_mfma_f32_16x16x32_bf16 v[36:39], v[64:67], v[76:79], v[36:39]
  v_mfma_f32_16x16x32_bf16 v[40:43], v[64:67], v[80:83], v[40:43]
  v_mfma_f32_16x16x32_bf16 v[44:47], v[68:71], v[72:75], v[44:47]
  v_mfma_f32_16x16x32_bf16 v[48:51], v[68:71], v[76:79], v[48:51]
  v_mfma_f32_16x16x32_bf16 v[52:55], v[68:71], v[80:83], v[52:55]
  s_waitcnt vmcnt(4)
  s_add_u32 s66, s90, 11
  s_bfe_u32 s67, s66, 0x20002
  s_mul_i32 s67, s67, 12288
  s_and_b32 s66, s66, 3
  s_lshl_b32 s66, s66, 8
  s_add_u32 s66, s66, s67
  v_add_u32 v17, s66, v14
  ds_read_b64_tr_b16 v[104:105], v12 offset:49152
  ds_read_b64_tr_b16 v[106:107], v12 offset:57344
  ds_read_b64_tr_b16 v[108:109], v13 offset:49152
  ds_read_b64_tr_b16 v[110:111], v13 offset:57344
  ds_read_b128 v[112:115], v17 offset:0
  ds_read_b128 v[116:119], v17 offset:4096
  ds_read_b128 v[120:123], v17 offset:8192
  s_waitcnt lgkmcnt(7)
  s_add_u32 s66, s90, 14
  s_and_b32 s66, s66, 15
  s_lshl_b32 s66, s66, 18
  s_add_u32 m0, s63, 32768
  s_add_u32 s66, s66, s70
  buffer_load_dwordx4 v15, s[16:19], s66 offen  lds
  s_add_u32 m0, s63, 40960
  s_add_u32 s66, s66, 0x8000
  buffer_load_dwordx4 v15, s[16:19], s66 offen  lds
  v_mfma_f32_16x16x32_bf16 v[32:35], v[84:87], v[92:95], v[32:35]
  v_mfma_f32_16x16x32_bf16 v[36:39], v[84:87], v[96:99], v[36:39]
  v_mfma_f32_16x16x32_bf16 v[40:43], v[84:87], v[100:103], v[40:43]
  v_mfma_f32_16x16x32_bf16 v[44:47], v[88:91], v[92:95], v[44:47]
  v_mfma_f32_16x16x32_bf16 v[48:51], v[88:91], v[96:99], v[48:51]
  v_mfma_f32_16x16x32_bf16 v[52:55], v[88:91], v[100:103], v[52:55]
  s_waitcnt vmcnt(4)
  s_add_u32 s66, s90, 12
  s_bfe_u32 s67, s66, 0x20002
  s_mul_i32 s67, s67, 12288
  s_and_b32 s66, s66, 3
  s_lshl_b32 s66, s66, 8
  s_add_u32 s66, s66, s67
  v_add_u32 v17, s66, v14
  ds_read_b64_tr_b16 v[64:65], v12 offset:0
  ds_read_b64_tr_b16 v[66:67], v12 offset:8192
  ds_read_b64_tr_b16 v[68:69], v13 offset:0
  ds_read_b64_tr_b16 v[70:71], v13 offset:8192
  ds_read_b128 v[72:75], v17 offset:0
  ds_read_b128 v[76:79], v17 offset:4096
  ds_read_b128 v[80:83], v17 offset:8192
  s_waitcnt lgkmcnt(7)
  s_add_u32 s66, s90, 15
  s_and_b32 s66, s66, 15
  s_lshl_b32 s66, s66, 18
  s_add_u32 m0, s63, 49152
  s_add_u32 s66, s66, s70
  buffer_load_dwordx4 v15, s[16:19], s66 offen  lds
  s_add_u32 m0, s63, 57344
  s_add_u32 s66, s66, 0x8000
  buffer_load_dwordx4 v15, s[16:19], s66 offen  lds
  s_add_u32 m0, s63, 0x10000
  s_add_u32 s69, s62, 0x0
  buffer_load_dwordx4 v7, s[8:11], s69 offen nt lds
  s_add_u32 m0, s63, 0x12000
  s_add_u32 s69, s62, 0x0
  buffer_load_dwordx4 v8, s[12:15], s69 offen nt lds
  s_add_u32 m0, s63, 0x14000
  s_add_u32 s69, s62, 0x2000
  buffer_load_dwordx4 v7, s[8:11], s69 offen nt lds
  s_add_u32 m0, s63, 0x16000
  s_add_u32 s69, s62, 0x2000
  buffer_load_dwordx4 v8, s[12:15], s69 offen nt lds
  v_mfma_f32_16x16x32_bf16 v[32:35], v[104:107], v[112:115], v[32:35]
  v_mfma_f32_16x16x32_bf16 v[36:39], v[104:107], v[116:119], v[36:39]
  v_mfma_f32_16x16x32_bf16 v[40:43], v[104:107], v[120:123], v[40:43]
  v_mfma_f32_16x16x32_bf16 v[44:47], v[108:111], v[112:115], v[44:47]
  v_mfma_f32_16x16x32_bf16 v[48:51], v[108:111], v[116:119], v[48:51]
  v_mfma_f32_16x16x32_bf16 v[52:55], v[108:111], v[120:123], v[52:55]
  s_waitcnt vmcnt(8)
  s_add_u32 s66, s90, 13
  s_bfe_u32 s67, s66, 0x20002
  s_mul_i32 s67, s67, 12288
  s_and_b32 s66, s66, 3
  s_lshl_b32 s66, s66, 8
  s_add_u32 s66, s66, s67
  v_add_u32 v17, s66, v14
  ds_read_b64_tr_b16 v[84:85], v12 offset:16384
  ds_read_b64_tr_b16 v[86:87], v12 offset:24576
  ds_read_b64_tr_b16 v[88:89], v13 offset:16384
  ds_read_b64_tr_b16 v[90:91], v13 offset:24576
  ds_read_b128 v[92:95], v17 offset:0
  ds_read_b128 v[96:99], v17 offset:4096
  ds_read_b128 v[100:103], v17 offset:8192
  s_waitcnt lgkmcnt(7)
  v_mfma_f32_16x16x32_bf16 v[32:35], v[64:67], v[72:75], v[32:35]
  v_mfma_f32_16x16x32_bf16 v[36:39], v[64:67], v[76:79], v[36:39]
  v_mfma_f32_16x16x32_bf16 v[40:43], v[64:67], v[80:83], v[40:43]
  v_mfma_f32_16x16x32_bf16 v[44:47], v[68:71], v[72:75], v[44:47]
  v_mfma_f32_16x16x32_bf16 v[48:51], v[68:71], v[76:79], v[48:51]
  v_mfma_f32_16x16x32_bf16 v[52:55], v[68:71], v[80:83], v[52:55]
  s_waitcnt vmcnt(6)
  s_add_u32 s66, s90, 14
  s_bfe_u32 s67, s66, 0x20002
  s_mul_i32 s67, s67, 12288
  s_and_b32 s66, s66, 3
  s_lshl_b32 s66, s66, 8
  s_add_u32 s66, s66, s67
  v_add_u32 v17, s66, v14
  ds_read_b64_tr_b16 v[104:105], v12 offset:32768
  ds_read_b64_tr_b16 v[106:107], v12 offset:40960
  ds_read_b64_tr_b16 v[108:109], v13 offset:32768
  ds_read_b64_tr_b16 v[110:111], v13 offset:40960
  ds_read_b128 v[112:115], v17 offset:0
  ds_read_b128 v[116:119], v17 offset:4096
  ds_read_b128 v[120:123], v17 offset:8192
  s_waitcnt lgkmcnt(7)
  v_mfma_f32_16x16x32_bf16 v[32:35], v[84:87], v[92:95], v[32:35]
  v_mfma_f32_16x16x32_bf16 v[36:39], v[84:87], v[96:99], v[36:39]
  v_mfma_f32_16x16x32_bf16 v[40:43], v[84:87], v[100:103], v[40:43]
  v_mfma_f32_16x16x32_bf16 v[44:47], v[88:91], v[92:95], v[44:47]
  v_mfma_f32_16x16x32_bf16 v[48:51], v[88:91], v[96:99], v[48:51]
  v_mfma_f32_16x16x32_bf16 v[52:55], v[88:91], v[100:103], v[52:55]
  s_waitcnt vmcnt(4)
  s_add_u32 s66, s90, 15
  s_bfe_u32 s67, s66, 0x20002
  s_mul_i32 s67, s67, 12288
  s_and_b32 s66, s66, 3
  s_lshl_b32 s66, s66, 8
  s_add_u32 s66, s66, s67
  v_add_u32 v17, s66, v14
  ds_read_b64_tr_b16 v[64:65], v12 offset:49152
  ds_read_b64_tr_b16 v[66:67], v12 offset:57344
  ds_read_b64_tr_b16 v[68:69], v13 offset:49152
  ds_read_b64_tr_b16 v[70:71], v13 offset:57344
  ds_read_b128 v[72:75], v17 offset:0
  ds_read_b128 v[76:79], v17 offset:4096
  ds_read_b128 v[80:83], v17 offset:8192
  s_waitcnt lgkmcnt(7)
  v_mfma_f32_16x16x32_bf16 v[32:35], v[104:107], v[112:115], v[32:35]
  v_mfma_f32_16x16x32_bf16 v[36:39], v[104:107], v[116:119], v[36:39]
  v_mfma_f32_16x16x32_bf16 v[40:43], v[104:107], v[120:123], v[40:43]
  v_mfma_f32_16x16x32_bf16 v[44:47], v[108:111], v[112:115], v[44:47]
  v_mfma_f32_16x16x32_bf16 v[48:51], v[108:111], v[116:119], v[48:51]
  v_mfma_f32_16x16x32_bf16 v[52:55], v[108:111], v[120:123], v[52:55]
  s_waitcnt lgkmcnt(0)
  v_mfma_f32_16x16x32_bf16 v[32:35], v[64:67], v[72:75], v[32:35]
  v_mfma_f32_16x16x32_bf16 v[36:39], v[64:67], v[76:79], v[36:39]
  v_mfma_f32_16x16x32_bf16 v[40:43], v[64:67], v[80:83], v[40:43]
  v_mfma_f32_16x16x32_bf16 v[44:47], v[68:71], v[72:75], v[44:47]
  v_mfma_f32_16x16x32_bf16 v[48:51], v[68:71], v[76:79], v[48:51]
  v_mfma_f32_16x16x32_bf16 v[52:55], v[68:71], v[80:83], v[52:55]
  s_mul_i32 s68, s58, 12288
  s_lshl_b32 s69, s57, 10
  s_add_u32 s68, s68, s69
  s_add_u32 s68, s68, 106496
  v_lshrrev_b32 v17, 1, v3
  v_lshlrev_b32 v17, 8, v17
  v_lshl_add_u32 v17, v2, 4, v17
  v_and_b32 v18, 1, v3
  v_lshl_add_u32 v17, v18, 3, v17
  v_add_u32 v17, s68, v17
  v_mul_f32 v32, s87, v32
  v_mul_f32 v33, s87, v33
  v_mul_f32 v34, s87, v34
  v_mul_f32 v35, s87, v35
  v_cvt_pk_bf16_f32 v64, v32, v33
  v_cvt_pk_bf16_f32 v65, v34, v35
  v_mul_f32 v36, s87, v36
  v_mul_f32 v37, s87, v37
  v_mul_f32 v38, s87, v38
  v_mul_f32 v39, s87, v39
  v_cvt_pk_bf16_f32 v66, v36, v37
  v_cvt_pk_bf16_f32 v67, v38, v39
  v_mul_f32 v40, s87, v40
  v_mul_f32 v41, s87, v41
  v_mul_f32 v42, s87, v42
  v_mul_f32 v43, s87, v43
  v_cvt_pk_bf16_f32 v68, v40, v41
  v_cvt_pk_bf16_f32 v69, v42, v43
  v_mul_f32 v44, s87, v44
  v_mul_f32 v45, s87, v45
  v_mul_f32 v46, s87, v46
  v_mul_f32 v47, s87, v47
  v_cvt_pk_bf16_f32 v70, v44, v45
  v_cvt_pk_bf16_f32 v71, v46, v47
  v_mul_f32 v48, s87, v48
  v_mul_f32 v49, s87, v49
  v_mul_f32 v50, s87, v50
  v_mul_f32 v51, s87, v51
  v_cvt_pk_bf16_f32 v72, v48, v49
  v_cvt_pk_bf16_f32 v73, v50, v51
  v_mul_f32 v52, s87, v52
  v_mul_f32 v53, s87, v53
  v_mul_f32 v54, s87, v54
  v_mul_f32 v55, s87, v55
  v_cvt_pk_bf16_f32 v74, v52, v53
  v_cvt_pk_bf16_f32 v75, v54, v55
  s_barrier
  ds_write_b64 v17, v[64:65] offset:0
  ds_write_b64 v17, v[66:67] offset:4096
  ds_write_b64 v17, v[68:69] offset:8192
  ds_write_b64 v17, v[70:71] offset:512
  ds_write_b64 v17, v[72:73] offset:4608
  ds_write_b64 v17, v[74:75] offset:8704
  s_add_u32 m0, s63, 0x0
  s_add_u32 s69, s62, 0x4000
  buffer_load_dwordx4 v7, s[8:11], s69 offen nt lds
  s_add_u32 m0, s63, 0x2000
  s_add_u32 s69, s62, 0x4000
  buffer_load_dwordx4 v8, s[12:15], s69 offen nt lds
  s_add_u32 m0, s63, 0x4000
  s_add_u32 s69, s62, 0x6000
  buffer_load_dwordx4 v7, s[8:11], s69 offen nt lds
  s_add_u32 m0, s63, 0x6000
  s_add_u32 s69, s62, 0x6000
  buffer_load_dwordx4 v8, s[12:15], s69 offen nt lds
  buffer_load_dwordx2 v[18:19], v28, s[28:31], 0 offen sc1
  s_and_b32 s66, s56, 1
  s_mul_i32 s66, s66, 12288
  s_add_u32 s66, s66, 106496
  v_add_u32 v16, s66, v0
  s_bfe_u32 s66, s56, 0x10001
  s_lshl_b32 s66, s66, 14
  v_add_u32 v4, s66, v4
  v_add_u32 v5, s66, v5
  v_add_u32 v6, s66, v6
  s_cmp_lg_u32 s58, 0
  s_cbranch_scc1 L_role1
L_role0:
  v_add_u32 v4, 65536, v4
  v_add_u32 v5, 65536, v5
  v_add_u32 v6, 65536, v6
  s_waitcnt vmcnt(5)
  s_waitcnt lgkmcnt(0)
  s_barrier
  ds_read_b128 v[112:115], v16 offset:0
  ds_read_b128 v[116:119], v16 offset:1024
  ds_read_b128 v[120:123], v16 offset:2048
  ds_read_b128 v[124:127], v16 offset:3072
  ds_read_b128 v[128:131], v16 offset:4096
  ds_read_b128 v[132:135], v16 offset:5120
  ds_read_b128 v[136:139], v16 offset:6144
  ds_read_b128 v[140:143], v16 offset:7168
  ds_read_b128 v[144:147], v16 offset:8192
  ds_read_b128 v[148:151], v16 offset:9216
  ds_read_b128 v[152:155], v16 offset:10240
  ds_read_b128 v[156:159], v16 offset:11264
  s_setprio 3
  ds_read_b128 v[56:59], v4 offset:0
  ds_read_b128 v[60:63], v4 offset:256
  ds_read_b128 v[64:67], v4 offset:512
  ds_read_b128 v[68:71], v4 offset:768
  ds_read_b128 v[72:75], v4 offset:4096
  ds_read_b128 v[76:79], v4 offset:4352
  ds_read_b128 v[80:83], v4 offset:4608
  ds_read_b128 v[84:87], v4 offset:4864
  s_add_u32 m0, s63, 0x8000
  s_add_u32 s69, s62, 0x8000
  buffer_load_dwordx4 v7, s[8:11], s69 offen nt lds
  s_add_u32 m0, s63, 0xa000
  s_add_u32 s69, s62, 0x8000
  buffer_load_dwordx4 v8, s[12:15], s69 offen nt lds
  s_add_u32 m0, s63, 0xc000
  s_add_u32 s69, s62, 0xa000
  buffer_load_dwordx4 v7, s[8:11], s69 offen nt lds
  s_add_u32 m0, s63, 0xe000
  s_add_u32 s69, s62, 0xa000
  buffer_load_dwordx4 v8, s[12:15], s69 offen nt lds
  s_add_u32 m0, s63, 0x20000
  s_add_u32 s69, s62, 0xc000
  buffer_load_dwordx4 v7, s[8:11], s69 offen nt lds
  s_add_u32 m0, s63, 0x22000
  s_add_u32 s69, s62, 0xc000
  buffer_load_dwordx4 v8, s[12:15], s69 offen nt lds
  s_add_u32 m0, s63, 0x24000
  s_add_u32 s69, s62, 0xe000
  buffer_load_dwordx4 v7, s[8:11], s69 offen nt lds
  s_add_u32 m0, s63, 0x26000
  s_add_u32 s69, s62, 0xe000
  buffer_load_dwordx4 v8, s[12:15], s69 offen nt lds
  s_waitcnt lgkmcnt(7)
  v_mfma_f32_16x16x32_bf16 v[88:91], v[56:59], v[112:115], 0
  s_waitcnt lgkmcnt(6)
  v_mfma_f32_16x16x32_bf16 v[88:91], v[60:63], v[116:119], v[88:91]
  s_waitcnt lgkmcnt(5)
  v_mfma_f32_16x16x32_bf16 v[88:91], v[64:67], v[120:123], v[88:91]
  s_waitcnt lgkmcnt(4)
  v_mfma_f32_16x16x32_bf16 v[88:91], v[68:71], v[124:127], v[88:91]
  s_waitcnt lgkmcnt(3)
  v_mfma_f32_16x16x32_bf16 v[100:103], v[72:75], v[112:115], 0
  s_waitcnt lgkmcnt(2)
  v_mfma_f32_16x16x32_bf16 v[100:103], v[76:79], v[116:119], v[100:103]
  s_waitcnt lgkmcnt(1)
  v_mfma_f32_16x16x32_bf16 v[100:103], v[80:83], v[120:123], v[100:103]
  s_waitcnt lgkmcnt(0)
  v_mfma_f32_16x16x32_bf16 v[100:103], v[84:87], v[124:127], v[100:103]
  v_mfma_f32_16x16x32_bf16 v[92:95], v[56:59], v[128:131], 0
  v_mfma_f32_16x16x32_bf16 v[92:95], v[60:63], v[132:135], v[92:95]
  v_mfma_f32_16x16x32_bf16 v[92:95], v[64:67], v[136:139], v[92:95]
  v_mfma_f32_16x16x32_bf16 v[92:95], v[68:71], v[140:143], v[92:95]
  v_mfma_f32_16x16x32_bf16 v[104:107], v[72:75], v[128:131], 0
  v_mfma_f32_16x16x32_bf16 v[104:107], v[76:79], v[132:135], v[104:107]
  v_mfma_f32_16x16x32_bf16 v[104:107], v[80:83], v[136:139], v[104:107]
  v_mfma_f32_16x16x32_bf16 v[104:107], v[84:87], v[140:143], v[104:107]
  v_mfma_f32_16x16x32_bf16 v[96:99], v[56:59], v[144:147], 0
  ds_read_b64_tr_b16 v[56:57], v5 offset:8192
  ds_read_b64_tr_b16 v[58:59], v5 offset:12288
  v_mfma_f32_16x16x32_bf16 v[96:99], v[60:63], v[148:151], v[96:99]
  ds_read_b64_tr_b16 v[60:61], v6 offset:8192
  ds_read_b64_tr_b16 v[62:63], v6 offset:12288
  v_mfma_f32_16x16x32_bf16 v[96:99], v[64:67], v[152:155], v[96:99]
  ds_read_b64_tr_b16 v[64:65], v5 offset:8704
  ds_read_b64_tr_b16 v[66:67], v5 offset:12800
  v_mfma_f32_16x16x32_bf16 v[96:99], v[68:71], v[156:159], v[96:99]
  ds_read_b64_tr_b16 v[68:69], v6 offset:8704
  ds_read_b64_tr_b16 v[70:71], v6 offset:12800
  v_mfma_f32_16x16x32_bf16 v[108:111], v[72:75], v[144:147], 0
  ds_read_b64_tr_b16 v[72:73], v5 offset:9216
  ds_read_b64_tr_b16 v[74:75], v5 offset:13312
  v_mfma_f32_16x16x32_bf16 v[108:111], v[76:79], v[148:151], v[108:111]
  ds_read_b64_tr_b16 v[76:77], v6 offset:9216
  ds_read_b64_tr_b16 v[78:79], v6 offset:13312
  v_mfma_f32_16x16x32_bf16 v[108:111], v[80:83], v[152:155], v[108:111]
  ds_read_b64_tr_b16 v[80:81], v5 offset:9728
  ds_read_b64_tr_b16 v[82:83], v5 offset:13824
  v_mfma_f32_16x16x32_bf16 v[108:111], v[84:87], v[156:159], v[108:111]
  ds_read_b64_tr_b16 v[84:85], v6 offset:9728
  ds_read_b64_tr_b16 v[86:87], v6 offset:13824
  v_max3_f32 v24, v88, v89, v90
  v_max3_f32 v24, v24, v91, v100
  v_max3_f32 v24, v24, v101, v102
  v_max_f32 v24, v24, v103
  v_mov_b32 v30, v24
  v_mov_b32 v31, v24
  s_nop 1
  v_permlane16_swap_b32 v30, v31
  s_nop 1
  v_max_f32 v30, v30, v31
  v_mov_b32 v31, v30
  s_nop 1
  v_permlane32_swap_b32 v30, v31
  s_nop 1
  v_max_f32 v24, v30, v31
  v_sub_f32 v32, 0, v24
  v_sub_f32 v33, 0, v24
  v_sub_f32 v34, 0, v24
  v_sub_f32 v35, 0, v24
  v_sub_f32 v88, v88, v24
  v_sub_f32 v89, v89, v24
  v_sub_f32 v90, v90, v24
  v_sub_f32 v91, v91, v24
  v_sub_f32 v100, v100, v24
  v_sub_f32 v101, v101, v24
  v_sub_f32 v102, v102, v24
  v_sub_f32 v103, v103, v24
  v_mov_b32 v9, 0
  v_exp_f32 v24, v88
  v_exp_f32 v25, v89
  v_exp_f32 v26, v90
  v_exp_f32 v27, v91
  v_add_f32 v12, v24, v25
  v_cvt_pk_bf16_f32 v44, v24, v25
  v_add_f32 v12, v12, v26
  v_exp_f32 v28, v100
  v_exp_f32 v29, v101
  v_cvt_pk_bf16_f32 v45, v26, v27
  v_add_f32 v12, v12, v27
  v_exp_f32 v30, v102
  v_exp_f32 v31, v103
  v_add_f32 v12, v12, v28
  v_cvt_pk_bf16_f32 v46, v28, v29
  v_add_f32 v12, v12, v29
  v_add_f32 v12, v12, v30
  v_cvt_pk_bf16_f32 v47, v30, v31
  v_add_f32 v12, v12, v31
  v_add_f32 v9, v9, v12
  v_max3_f32 v24, v92, v93, v94
  v_max3_f32 v24, v24, v95, v104
  v_max3_f32 v24, v24, v105, v106
  v_max_f32 v24, v24, v107
  v_mov_b32 v30, v24
  v_mov_b32 v31, v24
  s_nop 1
  v_permlane16_swap_b32 v30, v31
  s_nop 1
  v_max_f32 v30, v30, v31
  v_mov_b32 v31, v30
  s_nop 1
  v_permlane32_swap_b32 v30, v31
  s_nop 1
  v_max_f32 v24, v30, v31
  v_sub_f32 v36, 0, v24
  v_sub_f32 v37, 0, v24
  v_sub_f32 v38, 0, v24
  v_sub_f32 v39, 0, v24
  v_sub_f32 v92, v92, v24
  v_sub_f32 v93, v93, v24
  v_sub_f32 v94, v94, v24
  v_sub_f32 v95, v95, v24
  v_sub_f32 v104, v104, v24
  v_sub_f32 v105, v105, v24
  v_sub_f32 v106, v106, v24
  v_sub_f32 v107, v107, v24
  v_mov_b32 v10, 0
  v_exp_f32 v24, v92
  v_exp_f32 v25, v93
  v_exp_f32 v26, v94
  v_exp_f32 v27, v95
  v_add_f32 v13, v24, v25
  v_cvt_pk_bf16_f32 v48, v24, v25
  v_add_f32 v13, v13, v26
  v_exp_f32 v28, v104
  v_exp_f32 v29, v105
  v_cvt_pk_bf16_f32 v49, v26, v27
  v_add_f32 v13, v13, v27
  v_exp_f32 v30, v106
  v_exp_f32 v31, v107
  v_add_f32 v13, v13, v28
  v_cvt_pk_bf16_f32 v50, v28, v29
  v_add_f32 v13, v13, v29
  v_add_f32 v13, v13, v30
  v_cvt_pk_bf16_f32 v51, v30, v31
  v_add_f32 v13, v13, v31
  v_add_f32 v10, v10, v13
  v_max3_f32 v24, v96, v97, v98
  v_max3_f32 v24, v24, v99, v108
  v_max3_f32 v24, v24, v109, v110
  v_max_f32 v24, v24, v111
  v_mov_b32 v30, v24
  v_mov_b32 v31, v24
  s_nop 1
  v_permlane16_swap_b32 v30, v31
  s_nop 1
  v_max_f32 v30, v30, v31
  v_mov_b32 v31, v30
  s_nop 1
  v_permlane32_swap_b32 v30, v31
  s_nop 1
  v_max_f32 v24, v30, v31
  v_sub_f32 v40, 0, v24
  v_sub_f32 v41, 0, v24
  v_sub_f32 v42, 0, v24
  v_sub_f32 v43, 0, v24
  v_sub_f32 v96, v96, v24
  v_sub_f32 v97, v97, v24
  v_sub_f32 v98, v98, v24
  v_sub_f32 v99, v99, v24
  v_sub_f32 v108, v108, v24
  v_sub_f32 v109, v109, v24
  v_sub_f32 v110, v110, v24
  v_sub_f32 v111, v111, v24
  v_mov_b32 v11, 0
  v_exp_f32 v24, v96
  v_exp_f32 v25, v97
  v_exp_f32 v26, v98
  v_exp_f32 v27, v99
  v_add_f32 v14, v24, v25
  v_cvt_pk_bf16_f32 v52, v24, v25
  v_add_f32 v14, v14, v26
  v_exp_f32 v28, v108
  v_exp_f32 v29, v109
  v_cvt_pk_bf16_f32 v53, v26, v27
  v_add_f32 v14, v14, v27
  v_exp_f32 v30, v110
  v_exp_f32 v31, v111
  v_add_f32 v14, v14, v28
  v_cvt_pk_bf16_f32 v54, v28, v29
  v_add_f32 v14, v14, v29
  v_add_f32 v14, v14, v30
  v_cvt_pk_bf16_f32 v55, v30, v31
  v_add_f32 v14, v14, v31
  v_add_f32 v11, v11, v14
  v_add_u32 v4, 0xffff8000, v4
  v_add_u32 v5, 0xffff8000, v5
  v_add_u32 v6, 0xffff8000, v6
  s_waitcnt vmcnt(9)
  s_waitcnt lgkmcnt(0)
  s_barrier
  s_setprio 0
  v_mfma_f32_16x16x32_bf16 v[160:163], v[56:59], v[44:47], 0
  v_mfma_f32_16x16x32_bf16 v[172:175], v[60:63], v[44:47], 0
  v_mfma_f32_16x16x32_bf16 v[184:187], v[64:67], v[44:47], 0
  v_mfma_f32_16x16x32_bf16 v[196:199], v[68:71], v[44:47], 0
  v_mfma_f32_16x16x32_bf16 v[208:211], v[72:75], v[44:47], 0
  v_mfma_f32_16x16x32_bf16 v[220:223], v[76:79], v[44:47], 0
  v_mfma_f32_16x16x32_bf16 v[232:235], v[80:83], v[44:47], 0
  v_mfma_f32_16x16x32_bf16 v[244:247], v[84:87], v[44:47], 0
  v_mfma_f32_16x16x32_bf16 v[164:167], v[56:59], v[48:51], 0
  v_mfma_f32_16x16x32_bf16 v[176:179], v[60:63], v[48:51], 0
  v_mfma_f32_16x16x32_bf16 v[188:191], v[64:67], v[48:51], 0
  v_mfma_f32_16x16x32_bf16 v[200:203], v[68:71], v[48:51], 0
  v_mfma_f32_16x16x32_bf16 v[212:215], v[72:75], v[48:51], 0
  v_mfma_f32_16x16x32_bf16 v[224:227], v[76:79], v[48:51], 0
  v_mfma_f32_16x16x32_bf16 v[236:239], v[80:83], v[48:51], 0
  v_mfma_f32_16x16x32_bf16 v[248:251], v[84:87], v[48:51], 0
  s_nop 1
  v_mfma_f32_16x16x32_bf16 v[168:171], v[56:59], v[52:55], 0
  s_add_u32 m0, s63, 0x18000
  s_add_u32 s69, s62, 0x10000
  buffer_load_dwordx4 v7, s[8:11], s69 offen nt lds
  v_mfma_f32_16x16x32_bf16 v[180:183], v[60:63], v[52:55], 0
  s_add_u32 m0, s63, 0x1a000
  s_add_u32 s69, s62, 0x10000
  buffer_load_dwordx4 v8, s[12:15], s69 offen nt lds
  v_mfma_f32_16x16x32_bf16 v[192:195], v[64:67], v[52:55], 0
  s_add_u32 m0, s63, 0x1c000
  s_add_u32 s69, s62, 0x12000
  buffer_load_dwordx4 v7, s[8:11], s69 offen nt lds
  v_mfma_f32_16x16x32_bf16 v[204:207], v[68:71], v[52:55], 0
  s_add_u32 m0, s63, 0x1e000
  s_add_u32 s69, s62, 0x12000
  buffer_load_dwordx4 v8, s[12:15], s69 offen nt lds
  v_mfma_f32_16x16x32_bf16 v[216:219], v[72:75], v[52:55], 0
  s_add_u32 m0, s63, 0x10000
  s_add_u32 s69, s62, 0x14000
  buffer_load_dwordx4 v7, s[8:11], s69 offen nt lds
  v_mfma_f32_16x16x32_bf16 v[228:231], v[76:79], v[52:55], 0
  s_add_u32 m0, s63, 0x12000
  s_add_u32 s69, s62, 0x14000
  buffer_load_dwordx4 v8, s[12:15], s69 offen nt lds
  v_mfma_f32_16x16x32_bf16 v[240:243], v[80:83], v[52:55], 0
  s_add_u32 m0, s63, 0x14000
  s_add_u32 s69, s62, 0x16000
  buffer_load_dwordx4 v7, s[8:11], s69 offen nt lds
  v_mfma_f32_16x16x32_bf16 v[252:255], v[84:87], v[52:55], 0
  s_add_u32 m0, s63, 0x16000
  s_add_u32 s69, s62, 0x16000
  buffer_load_dwordx4 v8, s[12:15], s69 offen nt lds
  s_waitcnt vmcnt(12)
  s_waitcnt lgkmcnt(0)
  s_barrier
  s_setprio 3
  ds_read_b128 v[56:59], v4 offset:0
  ds_read_b128 v[60:63], v4 offset:256
  ds_read_b128 v[64:67], v4 offset:512
  ds_read_b128 v[68:71], v4 offset:768
  ds_read_b128 v[72:75], v4 offset:4096
  ds_read_b128 v[76:79], v4 offset:4352
  ds_read_b128 v[80:83], v4 offset:4608
  ds_read_b128 v[84:87], v4 offset:4864
  s_add_u32 m0, s63, 0x0
  s_add_u32 s69, s62, 0x18000
  buffer_load_dwordx4 v7, s[8:11], s69 offen nt lds
  s_add_u32 m0, s63, 0x2000
  s_add_u32 s69, s62, 0x18000
  buffer_load_dwordx4 v8, s[12:15], s69 offen nt lds
  s_add_u32 m0, s63, 0x4000
  s_add_u32 s69, s62, 0x1a000
  buffer_load_dwordx4 v7, s[8:11], s69 offen nt lds
  s_add_u32 m0, s63, 0x6000
  s_add_u32 s69, s62, 0x1a000
  buffer_load_dwordx4 v8, s[12:15], s69 offen nt lds
  s_waitcnt lgkmcnt(7)
  v_mfma_f32_16x16x32_bf16 v[88:91], v[56:59], v[112:115], v[32:35]
  s_waitcnt lgkmcnt(6)
  v_mfma_f32_16x16x32_bf16 v[88:91], v[60:63], v[116:119], v[88:91]
  s_waitcnt lgkmcnt(5)
  v_mfma_f32_16x16x32_bf16 v[88:91], v[64:67], v[120:123], v[88:91]
  s_waitcnt lgkmcnt(4)
  v_mfma_f32_16x16x32_bf16 v[88:91], v[68:71], v[124:127], v[88:91]
  s_waitcnt lgkmcnt(3)
  v_mfma_f32_16x16x32_bf16 v[100:103], v[72:75], v[112:115], v[32:35]
  s_waitcnt lgkmcnt(2)
  v_mfma_f32_16x16x32_bf16 v[100:103], v[76:79], v[116:119], v[100:103]
  s_waitcnt lgkmcnt(1)
  v_mfma_f32_16x16x32_bf16 v[100:103], v[80:83], v[120:123], v[100:103]
  s_waitcnt lgkmcnt(0)
  v_mfma_f32_16x16x32_bf16 v[100:103], v[84:87], v[124:127], v[100:103]
  v_mfma_f32_16x16x32_bf16 v[92:95], v[56:59], v[128:131], v[36:39]
  v_exp_f32 v24, v88
  v_exp_f32 v25, v89
  v_mfma_f32_16x16x32_bf16 v[92:95], v[60:63], v[132:135], v[92:95]
  v_exp_f32 v26, v90
  v_exp_f32 v27, v91
  v_mfma_f32_16x16x32_bf16 v[92:95], v[64:67], v[136:139], v[92:95]
  v_add_f32 v12, v24, v25
  v_cvt_pk_bf16_f32 v44, v24, v25
  v_mfma_f32_16x16x32_bf16 v[92:95], v[68:71], v[140:143], v[92:95]
  v_add_f32 v12, v12, v26
  v_exp_f32 v28, v100
  v_mfma_f32_16x16x32_bf16 v[104:107], v[72:75], v[128:131], v[36:39]
  v_exp_f32 v29, v101
  v_cvt_pk_bf16_f32 v45, v26, v27
  v_mfma_f32_16x16x32_bf16 v[104:107], v[76:79], v[132:135], v[104:107]
  v_add_f32 v12, v12, v27
  v_exp_f32 v30, v102
  v_mfma_f32_16x16x32_bf16 v[104:107], v[80:83], v[136:139], v[104:107]
  v_exp_f32 v31, v103
  v_add_f32 v12, v12, v28
  v_mfma_f32_16x16x32_bf16 v[104:107], v[84:87], v[140:143], v[104:107]
  v_cvt_pk_bf16_f32 v46, v28, v29
  v_add_f32 v12, v12, v29
  v_mfma_f32_16x16x32_bf16 v[96:99], v[56:59], v[144:147], v[40:43]
  ds_read_b64_tr_b16 v[56:57], v5 offset:8192
  ds_read_b64_tr_b16 v[58:59], v5 offset:12288
  v_add_f32 v12, v12, v30
  v_cvt_pk_bf16_f32 v47, v30, v31
  v_add_f32 v12, v12, v31
  v_mfma_f32_16x16x32_bf16 v[96:99], v[60:63], v[148:151], v[96:99]
  ds_read_b64_tr_b16 v[60:61], v6 offset:8192
  ds_read_b64_tr_b16 v[62:63], v6 offset:12288
  v_cmp_lt_f32 vcc, s72, v12
  s_cbranch_vccz Lok_1
  s_swappc_b64 s[76:77], s[78:79]
Lok_1:
  v_add_f32 v9, v9, v12
  v_mfma_f32_16x16x32_bf16 v[96:99], v[64:67], v[152:155], v[96:99]
  ds_read_b64_tr_b16 v[64:65], v5 offset:8704
  ds_read_b64_tr_b16 v[66:67], v5 offset:12800
  v_exp_f32 v24, v92
  v_exp_f32 v25, v93
  v_mfma_f32_16x16x32_bf16 v[96:99], v[68:71], v[156:159], v[96:99]
  ds_read_b64_tr_b16 v[68:69], v6 offset:8704
  ds_read_b64_tr_b16 v[70:71], v6 offset:12800
  v_exp_f32 v26, v94
  v_exp_f32 v27, v95
  v_mfma_f32_16x16x32_bf16 v[108:111], v[72:75], v[144:147], v[40:43]
  ds_read_b64_tr_b16 v[72:73], v5 offset:9216
  ds_read_b64_tr_b16 v[74:75], v5 offset:13312
  v_add_f32 v13, v24, v25
  v_cvt_pk_bf16_f32 v48, v24, v25
  v_mfma_f32_16x16x32_bf16 v[108:111], v[76:79], v[148:151], v[108:111]
  ds_read_b64_tr_b16 v[76:77], v6 offset:9216
  ds_read_b64_tr_b16 v[78:79], v6 offset:13312
  v_add_f32 v13, v13, v26
  v_exp_f32 v28, v104
  v_mfma_f32_16x16x32_bf16 v[108:111], v[80:83], v[152:155], v[108:111]
  ds_read_b64_tr_b16 v[80:81], v5 offset:9728
  ds_read_b64_tr_b16 v[82:83], v5 offset:13824
  v_exp_f32 v29, v105
  v_cvt_pk_bf16_f32 v49, v26, v27
  v_mfma_f32_16x16x32_bf16 v[108:111], v[84:87], v[156:159], v[108:111]
  ds_read_b64_tr_b16 v[84:85], v6 offset:9728
  ds_read_b64_tr_b16 v[86:87], v6 offset:13824
  v_add_f32 v13, v13, v27
  v_exp_f32 v30, v106
  v_add_u32 v4, 0x10000, v4
  v_add_u32 v5, 0x10000, v5
  v_add_u32 v6, 0x10000, v6
  v_exp_f32 v31, v107
  v_add_f32 v13, v13, v28
  v_cvt_pk_bf16_f32 v50, v28, v29
  v_add_f32 v13, v13, v29
  v_add_f32 v13, v13, v30
  v_cvt_pk_bf16_f32 v51, v30, v31
  v_add_f32 v13, v13, v31
  v_cmp_lt_f32 vcc, s72, v13
  s_cbranch_vccz Lok_2
  s_swappc_b64 s[76:77], s[80:81]
Lok_2:
  v_add_f32 v10, v10, v13
  s_waitcnt vmcnt(12)
  s_waitcnt lgkmcnt(0)
  s_barrier
  s_setprio 0
  v_mfma_f32_16x16x32_bf16 v[160:163], v[56:59], v[44:47], v[160:163]
  v_exp_f32 v24, v96
  v_exp_f32 v25, v97
  v_mfma_f32_16x16x32_bf16 v[172:175], v[60:63], v[44:47], v[172:175]
  v_exp_f32 v26, v98
  v_mfma_f32_16x16x32_bf16 v[184:187], v[64:67], v[44:47], v[184:187]
  v_exp_f32 v27, v99
  v_mfma_f32_16x16x32_bf16 v[196:199], v[68:71], v[44:47], v[196:199]
  v_add_f32 v14, v24, v25
  v_cvt_pk_bf16_f32 v52, v24, v25
  v_mfma_f32_16x16x32_bf16 v[208:211], v[72:75], v[44:47], v[208:211]
  v_add_f32 v14, v14, v26
  v_mfma_f32_16x16x32_bf16 v[220:223], v[76:79], v[44:47], v[220:223]
  v_exp_f32 v28, v108
  v_mfma_f32_16x16x32_bf16 v[232:235], v[80:83], v[44:47], v[232:235]
  v_exp_f32 v29, v109
  v_cvt_pk_bf16_f32 v53, v26, v27
  v_mfma_f32_16x16x32_bf16 v[244:247], v[84:87], v[44:47], v[244:247]
  v_add_f32 v14, v14, v27
  v_mfma_f32_16x16x32_bf16 v[164:167], v[56:59], v[48:51], v[164:167]
  v_exp_f32 v30, v110
  v_mfma_f32_16x16x32_bf16 v[176:179], v[60:63], v[48:51], v[176:179]
  v_exp_f32 v31, v111
  v_add_f32 v14, v14, v28
  v_mfma_f32_16x16x32_bf16 v[188:191], v[64:67], v[48:51], v[188:191]
  v_cvt_pk_bf16_f32 v54, v28, v29
  v_mfma_f32_16x16x32_bf16 v[200:203], v[68:71], v[48:51], v[200:203]
  v_add_f32 v14, v14, v29
  v_mfma_f32_16x16x32_bf16 v[212:215], v[72:75], v[48:51], v[212:215]
  v_add_f32 v14, v14, v30
  v_cvt_pk_bf16_f32 v55, v30, v31
  v_mfma_f32_16x16x32_bf16 v[224:227], v[76:79], v[48:51], v[224:227]
  v_add_f32 v14, v14, v31
  v_mfma_f32_16x16x32_bf16 v[236:239], v[80:83], v[48:51], v[236:239]
  v_cmp_lt_f32 vcc, s72, v14
  s_cbranch_vccz Lok_3
  s_swappc_b64 s[76:77], s[82:83]
Lok_3:
  v_mfma_f32_16x16x32_bf16 v[248:251], v[84:87], v[48:51], v[248:251]
  v_add_f32 v11, v11, v14
  s_nop 1
  v_mfma_f32_16x16x32_bf16 v[168:171], v[56:59], v[52:55], v[168:171]
  s_add_u32 m0, s63, 0x8000
  s_add_u32 s69, s62, 0x1c000
  buffer_load_dwordx4 v7, s[8:11], s69 offen nt lds
  v_mfma_f32_16x16x32_bf16 v[180:183], v[60:63], v[52:55], v[180:183]
  v_mfma_f32_16x16x32_bf16 v[192:195], v[64:67], v[52:55], v[192:195]
  s_add_u32 m0, s63, 0xa000
  s_add_u32 s69, s62, 0x1c000
  buffer_load_dwordx4 v8, s[12:15], s69 offen nt lds
  v_mfma_f32_16x16x32_bf16 v[204:207], v[68:71], v[52:55], v[204:207]
  v_mfma_f32_16x16x32_bf16 v[216:219], v[72:75], v[52:55], v[216:219]
  s_add_u32 m0, s63, 0xc000
  s_add_u32 s69, s62, 0x1e000
  buffer_load_dwordx4 v7, s[8:11], s69 offen nt lds
  v_mfma_f32_16x16x32_bf16 v[228:231], v[76:79], v[52:55], v[228:231]
  v_mfma_f32_16x16x32_bf16 v[240:243], v[80:83], v[52:55], v[240:243]
  s_add_u32 m0, s63, 0xe000
  s_add_u32 s69, s62, 0x1e000
  buffer_load_dwordx4 v8, s[12:15], s69 offen nt lds
  v_mfma_f32_16x16x32_bf16 v[252:255], v[84:87], v[52:55], v[252:255]
  s_waitcnt vmcnt(12)
  s_waitcnt lgkmcnt(0)
  s_barrier
  s_setprio 3
  ds_read_b128 v[56:59], v4 offset:0
  ds_read_b128 v[60:63], v4 offset:256
  ds_read_b128 v[64:67], v4 offset:512
  ds_read_b128 v[68:71], v4 offset:768
  ds_read_b128 v[72:75], v4 offset:4096
  ds_read_b128 v[76:79], v4 offset:4352
  ds_read_b128 v[80:83], v4 offset:4608
  ds_read_b128 v[84:87], v4 offset:4864
  s_add_u32 m0, s63, 0x20000
  s_add_u32 s69, s62, 0x20000
  buffer_load_dwordx4 v7, s[8:11], s69 offen nt lds
  s_add_u32 m0, s63, 0x22000
  s_add_u32 s69, s62, 0x20000
  buffer_load_dwordx4 v8, s[12:15], s69 offen nt lds
  s_add_u32 m0, s63, 0x24000
  s_add_u32 s69, s62, 0x22000
  buffer_load_dwordx4 v7, s[8:11], s69 offen nt lds
  s_add_u32 m0, s63, 0x26000
  s_add_u32 s69, s62, 0x22000
  buffer_load_dwordx4 v8, s[12:15], s69 offen nt lds
  s_waitcnt lgkmcnt(7)
  v_mfma_f32_16x16x32_bf16 v[88:91], v[56:59], v[112:115], v[32:35]
  s_waitcnt lgkmcnt(6)
  v_mfma_f32_16x16x32_bf16 v[88:91], v[60:63], v[116:119], v[88:91]
  s_waitcnt lgkmcnt(5)
  v_mfma_f32_16x16x32_bf16 v[88:91], v[64:67], v[120:123], v[88:91]
  s_waitcnt lgkmcnt(4)
  v_mfma_f32_16x16x32_bf16 v[88:91], v[68:71], v[124:127], v[88:91]
  s_waitcnt lgkmcnt(3)
  v_mfma_f32_16x16x32_bf16 v[100:103], v[72:75], v[112:115], v[32:35]
  s_waitcnt lgkmcnt(2)
  v_mfma_f32_16x16x32_bf16 v[100:103], v[76:79], v[116:119], v[100:103]
  s_waitcnt lgkmcnt(1)
  v_mfma_f32_16x16x32_bf16 v[100:103], v[80:83], v[120:123], v[100:103]
  s_waitcnt lgkmcnt(0)
  v_mfma_f32_16x16x32_bf16 v[100:103], v[84:87], v[124:127], v[100:103]
  v_mfma_f32_16x16x32_bf16 v[92:95], v[56:59], v[128:131], v[36:39]
  v_exp_f32 v24, v88
  v_exp_f32 v25, v89
  v_mfma_f32_16x16x32_bf16 v[92:95], v[60:63], v[132:135], v[92:95]
  v_exp_f32 v26, v90
  v_exp_f32 v27, v91
  v_mfma_f32_16x16x32_bf16 v[92:95], v[64:67], v[136:139], v[92:95]
  v_add_f32 v12, v24, v25
  v_cvt_pk_bf16_f32 v44, v24, v25
  v_mfma_f32_16x16x32_bf16 v[92:95], v[68:71], v[140:143], v[92:95]
  v_add_f32 v12, v12, v26
  v_exp_f32 v28, v100
  v_mfma_f32_16x16x32_bf16 v[104:107], v[72:75], v[128:131], v[36:39]
  v_exp_f32 v29, v101
  v_cvt_pk_bf16_f32 v45, v26, v27
  v_mfma_f32_16x16x32_bf16 v[104:107], v[76:79], v[132:135], v[104:107]
  v_add_f32 v12, v12, v27
  v_exp_f32 v30, v102
  v_mfma_f32_16x16x32_bf16 v[104:107], v[80:83], v[136:139], v[104:107]
  v_exp_f32 v31, v103
  v_add_f32 v12, v12, v28
  v_mfma_f32_16x16x32_bf16 v[104:107], v[84:87], v[140:143], v[104:107]
  v_cvt_pk_bf16_f32 v46, v28, v29
  v_add_f32 v12, v12, v29
  v_mfma_f32_16x16x32_bf16 v[96:99], v[56:59], v[144:147], v[40:43]
  ds_read_b64_tr_b16 v[56:57], v5 offset:8192
  ds_read_b64_tr_b16 v[58:59], v5 offset:12288
  v_add_f32 v12, v12, v30
  v_cvt_pk_bf16_f32 v47, v30, v31
  v_add_f32 v12, v12, v31
  v_mfma_f32_16x16x32_bf16 v[96:99], v[60:63], v[148:151], v[96:99]
  ds_read_b64_tr_b16 v[60:61], v6 offset:8192
  ds_read_b64_tr_b16 v[62:63], v6 offset:12288
  v_cmp_lt_f32 vcc, s72, v12
  s_cbranch_vccz Lok_4
  s_swappc_b64 s[76:77], s[78:79]
Lok_4:
  v_add_f32 v9, v9, v12
  v_mfma_f32_16x16x32_bf16 v[96:99], v[64:67], v[152:155], v[96:99]
  ds_read_b64_tr_b16 v[64:65], v5 offset:8704
  ds_read_b64_tr_b16 v[66:67], v5 offset:12800
  v_exp_f32 v24, v92
  v_exp_f32 v25, v93
  v_mfma_f32_16x16x32_bf16 v[96:99], v[68:71], v[156:159], v[96:99]
  ds_read_b64_tr_b16 v[68:69], v6 offset:8704
  ds_read_b64_tr_b16 v[70:71], v6 offset:12800
  v_exp_f32 v26, v94
  v_exp_f32 v27, v95
  v_mfma_f32_16x16x32_bf16 v[108:111], v[72:75], v[144:147], v[40:43]
  ds_read_b64_tr_b16 v[72:73], v5 offset:9216
  ds_read_b64_tr_b16 v[74:75], v5 offset:13312
  v_add_f32 v13, v24, v25
  v_cvt_pk_bf16_f32 v48, v24, v25
  v_mfma_f32_16x16x32_bf16 v[108:111], v[76:79], v[148:151], v[108:111]
  ds_read_b64_tr_b16 v[76:77], v6 offset:9216
  ds_read_b64_tr_b16 v[78:79], v6 offset:13312
  v_add_f32 v13, v13, v26
  v_exp_f32 v28, v104
  v_mfma_f32_16x16x32_bf16 v[108:111], v[80:83], v[152:155], v[108:111]
  ds_read_b64_tr_b16 v[80:81], v5 offset:9728
  ds_read_b64_tr_b16 v[82:83], v5 offset:13824
  v_exp_f32 v29, v105
  v_cvt_pk_bf16_f32 v49, v26, v27
  v_mfma_f32_16x16x32_bf16 v[108:111], v[84:87], v[156:159], v[108:111]
  ds_read_b64_tr_b16 v[84:85], v6 offset:9728
  ds_read_b64_tr_b16 v[86:87], v6 offset:13824
  v_add_f32 v13, v13, v27
  v_exp_f32 v30, v106
  v_add_u32 v4, 0xfffe8000, v4
  v_add_u32 v5, 0xfffe8000, v5
  v_add_u32 v6, 0xfffe8000, v6
  v_exp_f32 v31, v107
  v_add_f32 v13, v13, v28
  v_cvt_pk_bf16_f32 v50, v28, v29
  v_add_f32 v13, v13, v29
  v_add_f32 v13, v13, v30
  v_cvt_pk_bf16_f32 v51, v30, v31
  v_add_f32 v13, v13, v31
  v_cmp_lt_f32 vcc, s72, v13
  s_cbranch_vccz Lok_5
  s_swappc_b64 s[76:77], s[80:81]
Lok_5:
  v_add_f32 v10, v10, v13
  s_waitcnt vmcnt(12)
  s_waitcnt lgkmcnt(0)
  s_barrier
  s_setprio 0
  v_mfma_f32_16x16x32_bf16 v[160:163], v[56:59], v[44:47], v[160:163]
  v_exp_f32 v24, v96
  v_exp_f32 v25, v97
  v_mfma_f32_16x16x32_bf16 v[172:175], v[60:63], v[44:47], v[172:175]
  v_exp_f32 v26, v98
  v_mfma_f32_16x16x32_bf16 v[184:187], v[64:67], v[44:47], v[184:187]
  v_exp_f32 v27, v99
  v_mfma_f32_16x16x32_bf16 v[196:199], v[68:71], v[44:47], v[196:199]
  v_add_f32 v14, v24, v25
  v_cvt_pk_bf16_f32 v52, v24, v25
  v_mfma_f32_16x16x32_bf16 v[208:211], v[72:75], v[44:47], v[208:211]
  v_add_f32 v14, v14, v26
  v_mfma_f32_16x16x32_bf16 v[220:223], v[76:79], v[44:47], v[220:223]
  v_exp_f32 v28, v108
  v_mfma_f32_16x16x32_bf16 v[232:235], v[80:83], v[44:47], v[232:235]
  v_exp_f32 v29, v109
  v_cvt_pk_bf16_f32 v53, v26, v27
  v_mfma_f32_16x16x32_bf16 v[244:247], v[84:87], v[44:47], v[244:247]
  v_add_f32 v14, v14, v27
  v_mfma_f32_16x16x32_bf16 v[164:167], v[56:59], v[48:51], v[164:167]
  v_exp_f32 v30, v110
  v_mfma_f32_16x16x32_bf16 v[176:179], v[60:63], v[48:51], v[176:179]
  v_exp_f32 v31, v111
  v_add_f32 v14, v14, v28
  v_mfma_f32_16x16x32_bf16 v[188:191], v[64:67], v[48:51], v[188:191]
  v_cvt_pk_bf16_f32 v54, v28, v29
  v_mfma_f32_16x16x32_bf16 v[200:203], v[68:71], v[48:51], v[200:203]
  v_add_f32 v14, v14, v29
  v_mfma_f32_16x16x32_bf16 v[212:215], v[72:75], v[48:51], v[212:215]
  v_add_f32 v14, v14, v30
  v_cvt_pk_bf16_f32 v55, v30, v31
  v_mfma_f32_16x16x32_bf16 v[224:227], v[76:79], v[48:51], v[224:227]
  v_add_f32 v14, v14, v31
  v_mfma_f32_16x16x32_bf16 v[236:239], v[80:83], v[48:51], v[236:239]
  v_cmp_lt_f32 vcc, s72, v14
  s_cbranch_vccz Lok_6
  s_swappc_b64 s[76:77], s[82:83]
Lok_6:
  v_mfma_f32_16x16x32_bf16 v[248:251], v[84:87], v[48:51], v[248:251]
  v_add_f32 v11, v11, v14
  s_nop 1
  v_mfma_f32_16x16x32_bf16 v[168:171], v[56:59], v[52:55], v[168:171]
  s_add_u32 m0, s63, 0x18000
  s_add_u32 s69, s62, 0x24000
  buffer_load_dwordx4 v7, s[8:11], s69 offen nt lds
  v_mfma_f32_16x16x32_bf16 v[180:183], v[60:63], v[52:55], v[180:183]
  v_mfma_f32_16x16x32_bf16 v[192:195], v[64:67], v[52:55], v[192:195]
  s_add_u32 m0, s63, 0x1a000
  s_add_u32 s69, s62, 0x24000
  buffer_load_dwordx4 v8, s[12:15], s69 offen nt lds
  v_mfma_f32_16x16x32_bf16 v[204:207], v[68:71], v[52:55], v[204:207]
  v_mfma_f32_16x16x32_bf16 v[216:219], v[72:75], v[52:55], v[216:219]
  s_add_u32 m0, s63, 0x1c000
  s_add_u32 s69, s62, 0x26000
  buffer_load_dwordx4 v7, s[8:11], s69 offen nt lds
  v_mfma_f32_16x16x32_bf16 v[228:231], v[76:79], v[52:55], v[228:231]
  v_mfma_f32_16x16x32_bf16 v[240:243], v[80:83], v[52:55], v[240:243]
  s_add_u32 m0, s63, 0x1e000
  s_add_u32 s69, s62, 0x26000
  buffer_load_dwordx4 v8, s[12:15], s69 offen nt lds
  v_mfma_f32_16x16x32_bf16 v[252:255], v[84:87], v[52:55], v[252:255]
  s_waitcnt vmcnt(12)
  s_waitcnt lgkmcnt(0)
  s_barrier
  s_setprio 3
  ds_read_b128 v[56:59], v4 offset:0
  ds_read_b128 v[60:63], v4 offset:256
  ds_read_b128 v[64:67], v4 offset:512
  ds_read_b128 v[68:71], v4 offset:768
  ds_read_b128 v[72:75], v4 offset:4096
  ds_read_b128 v[76:79], v4 offset:4352
  ds_read_b128 v[80:83], v4 offset:4608
  ds_read_b128 v[84:87], v4 offset:4864
  s_add_u32 m0, s63, 0x10000
  s_add_u32 s69, s62, 0x28000
  buffer_load_dwordx4 v7, s[8:11], s69 offen nt lds
  s_add_u32 m0, s63, 0x12000
  s_add_u32 s69, s62, 0x28000
  buffer_load_dwordx4 v8, s[12:15], s69 offen nt lds
  s_add_u32 m0, s63, 0x14000
  s_add_u32 s69, s62, 0x2a000
  buffer_load_dwordx4 v7, s[8:11], s69 offen nt lds
  s_add_u32 m0, s63, 0x16000
  s_add_u32 s69, s62, 0x2a000
  buffer_load_dwordx4 v8, s[12:15], s69 offen nt lds
  s_waitcnt lgkmcnt(7)
  v_mfma_f32_16x16x32_bf16 v[88:91], v[56:59], v[112:115], v[32:35]
  s_waitcnt lgkmcnt(6)
  v_mfma_f32_16x16x32_bf16 v[88:91], v[60:63], v[116:119], v[88:91]
  s_waitcnt lgkmcnt(5)
  v_mfma_f32_16x16x32_bf16 v[88:91], v[64:67], v[120:123], v[88:91]
  s_waitcnt lgkmcnt(4)
  v_mfma_f32_16x16x32_bf16 v[88:91], v[68:71], v[124:127], v[88:91]
  s_waitcnt lgkmcnt(3)
  v_mfma_f32_16x16x32_bf16 v[100:103], v[72:75], v[112:115], v[32:35]
  s_waitcnt lgkmcnt(2)
  v_mfma_f32_16x16x32_bf16 v[100:103], v[76:79], v[116:119], v[100:103]
  s_waitcnt lgkmcnt(1)
  v_mfma_f32_16x16x32_bf16 v[100:103], v[80:83], v[120:123], v[100:103]
  s_waitcnt lgkmcnt(0)
  v_mfma_f32_16x16x32_bf16 v[100:103], v[84:87], v[124:127], v[100:103]
  v_mfma_f32_16x16x32_bf16 v[92:95], v[56:59], v[128:131], v[36:39]
  v_exp_f32 v24, v88
  v_exp_f32 v25, v89
  v_mfma_f32_16x16x32_bf16 v[92:95], v[60:63], v[132:135], v[92:95]
  v_exp_f32 v26, v90
  v_exp_f32 v27, v91
  v_mfma_f32_16x16x32_bf16 v[92:95], v[64:67], v[136:139], v[92:95]
  v_add_f32 v12, v24, v25
  v_cvt_pk_bf16_f32 v44, v24, v25
  v_mfma_f32_16x16x32_bf16 v[92:95], v[68:71], v[140:143], v[92:95]
  v_add_f32 v12, v12, v26
  v_exp_f32 v28, v100
  v_mfma_f32_16x16x32_bf16 v[104:107], v[72:75], v[128:131], v[36:39]
  v_exp_f32 v29, v101
  v_cvt_pk_bf16_f32 v45, v26, v27
  v_mfma_f32_16x16x32_bf16 v[104:107], v[76:79], v[132:135], v[104:107]
  v_add_f32 v12, v12, v27
  v_exp_f32 v30, v102
  v_mfma_f32_16x16x32_bf16 v[104:107], v[80:83], v[136:139], v[104:107]
  v_exp_f32 v31, v103
  v_add_f32 v12, v12, v28
  v_mfma_f32_16x16x32_bf16 v[104:107], v[84:87], v[140:143], v[104:107]
  v_cvt_pk_bf16_f32 v46, v28, v29
  v_add_f32 v12, v12, v29
  v_mfma_f32_16x16x32_bf16 v[96:99], v[56:59], v[144:147], v[40:43]
  ds_read_b64_tr_b16 v[56:57], v5 offset:8192
  ds_read_b64_tr_b16 v[58:59], v5 offset:12288
  v_add_f32 v12, v12, v30
  v_cvt_pk_bf16_f32 v47, v30, v31
  v_add_f32 v12, v12, v31
  v_mfma_f32_16x16x32_bf16 v[96:99], v[60:63], v[148:151], v[96:99]
  ds_read_b64_tr_b16 v[60:61], v6 offset:8192
  ds_read_b64_tr_b16 v[62:63], v6 offset:12288
  v_cmp_lt_f32 vcc, s72, v12
  s_cbranch_vccz Lok_7
  s_swappc_b64 s[76:77], s[78:79]
Lok_7:
  v_add_f32 v9, v9, v12
  v_mfma_f32_16x16x32_bf16 v[96:99], v[64:67], v[152:155], v[96:99]
  ds_read_b64_tr_b16 v[64:65], v5 offset:8704
  ds_read_b64_tr_b16 v[66:67], v5 offset:12800
  v_exp_f32 v24, v92
  v_exp_f32 v25, v93
  v_mfma_f32_16x16x32_bf16 v[96:99], v[68:71], v[156:159], v[96:99]
  ds_read_b64_tr_b16 v[68:69], v6 offset:8704
  ds_read_b64_tr_b16 v[70:71], v6 offset:12800
  v_exp_f32 v26, v94
  v_exp_f32 v27, v95
  v_mfma_f32_16x16x32_bf16 v[108:111], v[72:75], v[144:147], v[40:43]
  ds_read_b64_tr_b16 v[72:73], v5 offset:9216
  ds_read_b64_tr_b16 v[74:75], v5 offset:13312
  v_add_f32 v13, v24, v25
  v_cvt_pk_bf16_f32 v48, v24, v25
  v_mfma_f32_16x16x32_bf16 v[108:111], v[76:79], v[148:151], v[108:111]
  ds_read_b64_tr_b16 v[76:77], v6 offset:9216
  ds_read_b64_tr_b16 v[78:79], v6 offset:13312
  v_add_f32 v13, v13, v26
  v_exp_f32 v28, v104
  v_mfma_f32_16x16x32_bf16 v[108:111], v[80:83], v[152:155], v[108:111]
  ds_read_b64_tr_b16 v[80:81], v5 offset:9728
  ds_read_b64_tr_b16 v[82:83], v5 offset:13824
  v_exp_f32 v29, v105
  v_cvt_pk_bf16_f32 v49, v26, v27
  v_mfma_f32_16x16x32_bf16 v[108:111], v[84:87], v[156:159], v[108:111]
  ds_read_b64_tr_b16 v[84:85], v6 offset:9728
  ds_read_b64_tr_b16 v[86:87], v6 offset:13824
  v_add_f32 v13, v13, v27
  v_exp_f32 v30, v106
  v_add_u32 v4, 0x20000, v4
  v_add_u32 v5, 0x20000, v5
  v_add_u32 v6, 0x20000, v6
  v_exp_f32 v31, v107
  v_add_f32 v13, v13, v28
  v_cvt_pk_bf16_f32 v50, v28, v29
  v_add_f32 v13, v13, v29
  v_add_f32 v13, v13, v30
  v_cvt_pk_bf16_f32 v51, v30, v31
  v_add_f32 v13, v13, v31
  v_cmp_lt_f32 vcc, s72, v13
  s_cbranch_vccz Lok_8
  s_swappc_b64 s[76:77], s[80:81]
Lok_8:
  v_add_f32 v10, v10, v13
  s_waitcnt vmcnt(12)
  s_waitcnt lgkmcnt(0)
  s_barrier
  s_setprio 0
  v_mfma_f32_16x16x32_bf16 v[160:163], v[56:59], v[44:47], v[160:163]
  v_exp_f32 v24, v96
  v_exp_f32 v25, v97
  v_mfma_f32_16x16x32_bf16 v[172:175], v[60:63], v[44:47], v[172:175]
  v_exp_f32 v26, v98
  v_mfma_f32_16x16x32_bf16 v[184:187], v[64:67], v[44:47], v[184:187]
  v_exp_f32 v27, v99
  v_mfma_f32_16x16x32_bf16 v[196:199], v[68:71], v[44:47], v[196:199]
  v_add_f32 v14, v24, v25
  v_cvt_pk_bf16_f32 v52, v24, v25
  v_mfma_f32_16x16x32_bf16 v[208:211], v[72:75], v[44:47], v[208:211]
  v_add_f32 v14, v14, v26
  v_mfma_f32_16x16x32_bf16 v[220:223], v[76:79], v[44:47], v[220:223]
  v_exp_f32 v28, v108
  v_mfma_f32_16x16x32_bf16 v[232:235], v[80:83], v[44:47], v[232:235]
  v_exp_f32 v29, v109
  v_cvt_pk_bf16_f32 v53, v26, v27
  v_mfma_f32_16x16x32_bf16 v[244:247], v[84:87], v[44:47], v[244:247]
  v_add_f32 v14, v14, v27
  v_mfma_f32_16x16x32_bf16 v[164:167], v[56:59], v[48:51], v[164:167]
  v_exp_f32 v30, v110
  v_mfma_f32_16x16x32_bf16 v[176:179], v[60:63], v[48:51], v[176:179]
  v_exp_f32 v31, v111
  v_add_f32 v14, v14, v28
  v_mfma_f32_16x16x32_bf16 v[188:191], v[64:67], v[48:51], v[188:191]
  v_cvt_pk_bf16_f32 v54, v28, v29
  v_mfma_f32_16x16x32_bf16 v[200:203], v[68:71], v[48:51], v[200:203]
  v_add_f32 v14, v14, v29
  v_mfma_f32_16x16x32_bf16 v[212:215], v[72:75], v[48:51], v[212:215]
  v_add_f32 v14, v14, v30
  v_cvt_pk_bf16_f32 v55, v30, v31
  v_mfma_f32_16x16x32_bf16 v[224:227], v[76:79], v[48:51], v[224:227]
  v_add_f32 v14, v14, v31
  v_mfma_f32_16x16x32_bf16 v[236:239], v[80:83], v[48:51], v[236:239]
  v_cmp_lt_f32 vcc, s72, v14
  s_cbranch_vccz Lok_9
  s_swappc_b64 s[76:77], s[82:83]
Lok_9:
  v_mfma_f32_16x16x32_bf16 v[248:251], v[84:87], v[48:51], v[248:251]
  v_add_f32 v11, v11, v14
  s_nop 1
  v_mfma_f32_16x16x32_bf16 v[168:171], v[56:59], v[52:55], v[168:171]
  s_add_u32 m0, s63, 0x0
  s_add_u32 s69, s62, 0x2c000
  buffer_load_dwordx4 v7, s[8:11], s69 offen nt lds
  v_mfma_f32_16x16x32_bf16 v[180:183], v[60:63], v[52:55], v[180:183]
  v_mfma_f32_16x16x32_bf16 v[192:195], v[64:67], v[52:55], v[192:195]
  s_add_u32 m0, s63, 0x2000
  s_add_u32 s69, s62, 0x2c000
  buffer_load_dwordx4 v8, s[12:15], s69 offen nt lds
  v_mfma_f32_16x16x32_bf16 v[204:207], v[68:71], v[52:55], v[204:207]
  v_mfma_f32_16x16x32_bf16 v[216:219], v[72:75], v[52:55], v[216:219]
  s_add_u32 m0, s63, 0x4000
  s_add_u32 s69, s62, 0x2e000
  buffer_load_dwordx4 v7, s[8:11], s69 offen nt lds
  v_mfma_f32_16x16x32_bf16 v[228:231], v[76:79], v[52:55], v[228:231]
  v_mfma_f32_16x16x32_bf16 v[240:243], v[80:83], v[52:55], v[240:243]
  s_add_u32 m0, s63, 0x6000
  s_add_u32 s69, s62, 0x2e000
  buffer_load_dwordx4 v8, s[12:15], s69 offen nt lds
  v_mfma_f32_16x16x32_bf16 v[252:255], v[84:87], v[52:55], v[252:255]
  s_waitcnt vmcnt(12)
  s_waitcnt lgkmcnt(0)
  s_barrier
  s_setprio 3
  ds_read_b128 v[56:59], v4 offset:0
  ds_read_b128 v[60:63], v4 offset:256
  ds_read_b128 v[64:67], v4 offset:512
  ds_read_b128 v[68:71], v4 offset:768
  ds_read_b128 v[72:75], v4 offset:4096
  ds_read_b128 v[76:79], v4 offset:4352
  ds_read_b128 v[80:83], v4 offset:4608
  ds_read_b128 v[84:87], v4 offset:4864
  s_add_u32 m0, s63, 0x8000
  s_add_u32 s69, s62, 0x30000
  buffer_load_dwordx4 v7, s[8:11], s69 offen nt lds
  s_add_u32 m0, s63, 0xa000
  s_add_u32 s69, s62, 0x30000
  buffer_load_dwordx4 v8, s[12:15], s69 offen nt lds
  s_add_u32 m0, s63, 0xc000
  s_add_u32 s69, s62, 0x32000
  buffer_load_dwordx4 v7, s[8:11], s69 offen nt lds
  s_add_u32 m0, s63, 0xe000
  s_add_u32 s69, s62, 0x32000
  buffer_load_dwordx4 v8, s[12:15], s69 offen nt lds
  s_waitcnt lgkmcnt(7)
  v_mfma_f32_16x16x32_bf16 v[88:91], v[56:59], v[112:115], v[32:35]
  s_waitcnt lgkmcnt(6)
  v_mfma_f32_16x16x32_bf16 v[88:91], v[60:63], v[116:119], v[88:91]
  s_waitcnt lgkmcnt(5)
  v_mfma_f32_16x16x32_bf16 v[88:91], v[64:67], v[120:123], v[88:91]
  s_waitcnt lgkmcnt(4)
  v_mfma_f32_16x16x32_bf16 v[88:91], v[68:71], v[124:127], v[88:91]
  s_waitcnt lgkmcnt(3)
  v_mfma_f32_16x16x32_bf16 v[100:103], v[72:75], v[112:115], v[32:35]
  s_waitcnt lgkmcnt(2)
  v_mfma_f32_16x16x32_bf16 v[100:103], v[76:79], v[116:119], v[100:103]
  s_waitcnt lgkmcnt(1)
  v_mfma_f32_16x16x32_bf16 v[100:103], v[80:83], v[120:123], v[100:103]
  s_waitcnt lgkmcnt(0)
  v_mfma_f32_16x16x32_bf16 v[100:103], v[84:87], v[124:127], v[100:103]
  v_mfma_f32_16x16x32_bf16 v[92:95], v[56:59], v[128:131], v[36:39]
  v_exp_f32 v24, v88
  v_exp_f32 v25, v89
  v_mfma_f32_16x16x32_bf16 v[92:95], v[60:63], v[132:135], v[92:95]
  v_exp_f32 v26, v90
  v_exp_f32 v27, v91
  v_mfma_f32_16x16x32_bf16 v[92:95], v[64:67], v[136:139], v[92:95]
  v_add_f32 v12, v24, v25
  v_cvt_pk_bf16_f32 v44, v24, v25
  v_mfma_f32_16x16x32_bf16 v[92:95], v[68:71], v[140:143], v[92:95]
  v_add_f32 v12, v12, v26
  v_exp_f32 v28, v100
  v_mfma_f32_16x16x32_bf16 v[104:107], v[72:75], v[128:131], v[36:39]
  v_exp_f32 v29, v101
  v_cvt_pk_bf16_f32 v45, v26, v27
  v_mfma_f32_16x16x32_bf16 v[104:107], v[76:79], v[132:135], v[104:107]
  v_add_f32 v12, v12, v27
  v_exp_f32 v30, v102
  v_mfma_f32_16x16x32_bf16 v[104:107], v[80:83], v[136:139], v[104:107]
  v_exp_f32 v31, v103
  v_add_f32 v12, v12, v28
  v_mfma_f32_16x16x32_bf16 v[104:107], v[84:87], v[140:143], v[104:107]
  v_cvt_pk_bf16_f32 v46, v28, v29
  v_add_f32 v12, v12, v29
  v_mfma_f32_16x16x32_bf16 v[96:99], v[56:59], v[144:147], v[40:43]
  ds_read_b64_tr_b16 v[56:57], v5 offset:8192
  ds_read_b64_tr_b16 v[58:59], v5 offset:12288
  v_add_f32 v12, v12, v30
  v_cvt_pk_bf16_f32 v47, v30, v31
  v_add_f32 v12, v12, v31
  v_mfma_f32_16x16x32_bf16 v[96:99], v[60:63], v[148:151], v[96:99]
  ds_read_b64_tr_b16 v[60:61], v6 offset:8192
  ds_read_b64_tr_b16 v[62:63], v6 offset:12288
  v_cmp_lt_f32 vcc, s72, v12
  s_cbranch_vccz Lok_10
  s_swappc_b64 s[76:77], s[78:79]
Lok_10:
  v_add_f32 v9, v9, v12
  v_mfma_f32_16x16x32_bf16 v[96:99], v[64:67], v[152:155], v[96:99]
  ds_read_b64_tr_b16 v[64:65], v5 offset:8704
  ds_read_b64_tr_b16 v[66:67], v5 offset:12800
  v_exp_f32 v24, v92
  v_exp_f32 v25, v93
  v_mfma_f32_16x16x32_bf16 v[96:99], v[68:71], v[156:159], v[96:99]
  ds_read_b64_tr_b16 v[68:69], v6 offset:8704
  ds_read_b64_tr_b16 v[70:71], v6 offset:12800
  v_exp_f32 v26, v94
  v_exp_f32 v27, v95
  v_mfma_f32_16x16x32_bf16 v[108:111], v[72:75], v[144:147], v[40:43]
  ds_read_b64_tr_b16 v[72:73], v5 offset:9216
  ds_read_b64_tr_b16 v[74:75], v5 offset:13312
  v_add_f32 v13, v24, v25
  v_cvt_pk_bf16_f32 v48, v24, v25
  v_mfma_f32_16x16x32_bf16 v[108:111], v[76:79], v[148:151], v[108:111]
  ds_read_b64_tr_b16 v[76:77], v6 offset:9216
  ds_read_b64_tr_b16 v[78:79], v6 offset:13312
  v_add_f32 v13, v13, v26
  v_exp_f32 v28, v104
  v_mfma_f32_16x16x32_bf16 v[108:111], v[80:83], v[152:155], v[108:111]
  ds_read_b64_tr_b16 v[80:81], v5 offset:9728
  ds_read_b64_tr_b16 v[82:83], v5 offset:13824
  v_exp_f32 v29, v105
  v_cvt_pk_bf16_f32 v49, v26, v27
  v_mfma_f32_16x16x32_bf16 v[108:111], v[84:87], v[156:159], v[108:111]
  ds_read_b64_tr_b16 v[84:85], v6 offset:9728
  ds_read_b64_tr_b16 v[86:87], v6 offset:13824
  v_add_f32 v13, v13, v27
  v_exp_f32 v30, v106
  v_add_u32 v4, 0xffff0000, v4
  v_add_u32 v5, 0xffff0000, v5
  v_add_u32 v6, 0xffff0000, v6
  v_exp_f32 v31, v107
  v_add_f32 v13, v13, v28
  v_cvt_pk_bf16_f32 v50, v28, v29
  v_add_f32 v13, v13, v29
  v_add_f32 v13, v13, v30
  v_cvt_pk_bf16_f32 v51, v30, v31
  v_add_f32 v13, v13, v31
  v_cmp_lt_f32 vcc, s72, v13
  s_cbranch_vccz Lok_11
  s_swappc_b64 s[76:77], s[80:81]
Lok_11:
  v_add_f32 v10, v10, v13
  s_waitcnt vmcnt(12)
  s_waitcnt lgkmcnt(0)
  s_barrier
  s_setprio 0
  v_mfma_f32_16x16x32_bf16 v[160:163], v[56:59], v[44:47], v[160:163]
  v_exp_f32 v24, v96
  v_exp_f32 v25, v97
  v_mfma_f32_16x16x32_bf16 v[172:175], v[60:63], v[44:47], v[172:175]
  v_exp_f32 v26, v98
  v_mfma_f32_16x16x32_bf16 v[184:187], v[64:67], v[44:47], v[184:187]
  v_exp_f32 v27, v99
  v_mfma_f32_16x16x32_bf16 v[196:199], v[68:71], v[44:47], v[196:199]
  v_add_f32 v14, v24, v25
  v_cvt_pk_bf16_f32 v52, v24, v25
  v_mfma_f32_16x16x32_bf16 v[208:211], v[72:75], v[44:47], v[208:211]
  v_add_f32 v14, v14, v26
  v_mfma_f32_16x16x32_bf16 v[220:223], v[76:79], v[44:47], v[220:223]
  v_exp_f32 v28, v108
  v_mfma_f32_16x16x32_bf16 v[232:235], v[80:83], v[44:47], v[232:235]
  v_exp_f32 v29, v109
  v_cvt_pk_bf16_f32 v53, v26, v27
  v_mfma_f32_16x16x32_bf16 v[244:247], v[84:87], v[44:47], v[244:247]
  v_add_f32 v14, v14, v27
  v_mfma_f32_16x16x32_bf16 v[164:167], v[56:59], v[48:51], v[164:167]
  v_exp_f32 v30, v110
  v_mfma_f32_16x16x32_bf16 v[176:179], v[60:63], v[48:51], v[176:179]
  v_exp_f32 v31, v111
  v_add_f32 v14, v14, v28
  v_mfma_f32_16x16x32_bf16 v[188:191], v[64:67], v[48:51], v[188:191]
  v_cvt_pk_bf16_f32 v54, v28, v29
  v_mfma_f32_16x16x32_bf16 v[200:203], v[68:71], v[48:51], v[200:203]
  v_add_f32 v14, v14, v29
  v_mfma_f32_16x16x32_bf16 v[212:215], v[72:75], v[48:51], v[212:215]
  v_add_f32 v14, v14, v30
  v_cvt_pk_bf16_f32 v55, v30, v31
  v_mfma_f32_16x16x32_bf16 v[224:227], v[76:79], v[48:51], v[224:227]
  v_add_f32 v14, v14, v31
  v_mfma_f32_16x16x32_bf16 v[236:239], v[80:83], v[48:51], v[236:239]
  v_cmp_lt_f32 vcc, s72, v14
  s_cbranch_vccz Lok_12
  s_swappc_b64 s[76:77], s[82:83]
Lok_12:
  v_mfma_f32_16x16x32_bf16 v[248:251], v[84:87], v[48:51], v[248:251]
  v_add_f32 v11, v11, v14
  s_nop 1
  v_mfma_f32_16x16x32_bf16 v[168:171], v[56:59], v[52:55], v[168:171]
  s_add_u32 m0, s63, 0x20000
  s_add_u32 s69, s62, 0x34000
  buffer_load_dwordx4 v7, s[8:11], s69 offen nt lds
  v_mfma_f32_16x16x32_bf16 v[180:183], v[60:63], v[52:55], v[180:183]
  v_mfma_f32_16x16x32_bf16 v[192:195], v[64:67], v[52:55], v[192:195]
  s_add_u32 m0, s63, 0x22000
  s_add_u32 s69, s62, 0x34000
  buffer_load_dwordx4 v8, s[12:15], s69 offen nt lds
  v_mfma_f32_16x16x32_bf16 v[204:207], v[68:71], v[52:55], v[204:207]
  v_mfma_f32_16x16x32_bf16 v[216:219], v[72:75], v[52:55], v[216:219]
  s_add_u32 m0, s63, 0x24000
  s_add_u32 s69, s62, 0x36000
  buffer_load_dwordx4 v7, s[8:11], s69 offen nt lds
  v_mfma_f32_16x16x32_bf16 v[228:231], v[76:79], v[52:55], v[228:231]
  v_mfma_f32_16x16x32_bf16 v[240:243], v[80:83], v[52:55], v[240:243]
  s_add_u32 m0, s63, 0x26000
  s_add_u32 s69, s62, 0x36000
  buffer_load_dwordx4 v8, s[12:15], s69 offen nt lds
  v_mfma_f32_16x16x32_bf16 v[252:255], v[84:87], v[52:55], v[252:255]
  s_waitcnt vmcnt(12)
  s_waitcnt lgkmcnt(0)
  s_barrier
  s_setprio 3
  ds_read_b128 v[56:59], v4 offset:0
  ds_read_b128 v[60:63], v4 offset:256
  ds_read_b128 v[64:67], v4 offset:512
  ds_read_b128 v[68:71], v4 offset:768
  ds_read_b128 v[72:75], v4 offset:4096
  ds_read_b128 v[76:79], v4 offset:4352
  ds_read_b128 v[80:83], v4 offset:4608
  ds_read_b128 v[84:87], v4 offset:4864
  s_add_u32 m0, s63, 0x18000
  s_add_u32 s69, s62, 0x38000
  buffer_load_dwordx4 v7, s[8:11], s69 offen nt lds
  s_add_u32 m0, s63, 0x1a000
  s_add_u32 s69, s62, 0x38000
  buffer_load_dwordx4 v8, s[12:15], s69 offen nt lds
  s_add_u32 m0, s63, 0x1c000
  s_add_u32 s69, s62, 0x3a000
  buffer_load_dwordx4 v7, s[8:11], s69 offen nt lds
  s_add_u32 m0, s63, 0x1e000
  s_add_u32 s69, s62, 0x3a000
  buffer_load_dwordx4 v8, s[12:15], s69 offen nt lds
  s_waitcnt lgkmcnt(7)
  v_mfma_f32_16x16x32_bf16 v[88:91], v[56:59], v[112:115], v[32:35]
  s_waitcnt lgkmcnt(6)
  v_mfma_f32_16x16x32_bf16 v[88:91], v[60:63], v[116:119], v[88:91]
  s_waitcnt lgkmcnt(5)
  v_mfma_f32_16x16x32_bf16 v[88:91], v[64:67], v[120:123], v[88:91]
  s_waitcnt lgkmcnt(4)
  v_mfma_f32_16x16x32_bf16 v[88:91], v[68:71], v[124:127], v[88:91]
  s_waitcnt lgkmcnt(3)
  v_mfma_f32_16x16x32_bf16 v[100:103], v[72:75], v[112:115], v[32:35]
  s_waitcnt lgkmcnt(2)
  v_mfma_f32_16x16x32_bf16 v[100:103], v[76:79], v[116:119], v[100:103]
  s_waitcnt lgkmcnt(1)
  v_mfma_f32_16x16x32_bf16 v[100:103], v[80:83], v[120:123], v[100:103]
  s_waitcnt lgkmcnt(0)
  v_mfma_f32_16x16x32_bf16 v[100:103], v[84:87], v[124:127], v[100:103]
  v_mfma_f32_16x16x32_bf16 v[92:95], v[56:59], v[128:131], v[36:39]
  v_exp_f32 v24, v88
  v_exp_f32 v25, v89
  v_mfma_f32_16x16x32_bf16 v[92:95], v[60:63], v[132:135], v[92:95]
  v_exp_f32 v26, v90
  v_exp_f32 v27, v91
  v_mfma_f32_16x16x32_bf16 v[92:95], v[64:67], v[136:139], v[92:95]
  v_add_f32 v12, v24, v25
  v_cvt_pk_bf16_f32 v44, v24, v25
  v_mfma_f32_16x16x32_bf16 v[92:95], v[68:71], v[140:143], v[92:95]
  v_add_f32 v12, v12, v26
  v_exp_f32 v28, v100
  v_mfma_f32_16x16x32_bf16 v[104:107], v[72:75], v[128:131], v[36:39]
  v_exp_f32 v29, v101
  v_cvt_pk_bf16_f32 v45, v26, v27
  v_mfma_f32_16x16x32_bf16 v[104:107], v[76:79], v[132:135], v[104:107]
  v_add_f32 v12, v12, v27
  v_exp_f32 v30, v102
  v_mfma_f32_16x16x32_bf16 v[104:107], v[80:83], v[136:139], v[104:107]
  v_exp_f32 v31, v103
  v_add_f32 v12, v12, v28
  v_mfma_f32_16x16x32_bf16 v[104:107], v[84:87], v[140:143], v[104:107]
  v_cvt_pk_bf16_f32 v46, v28, v29
  v_add_f32 v12, v12, v29
  v_mfma_f32_16x16x32_bf16 v[96:99], v[56:59], v[144:147], v[40:43]
  ds_read_b64_tr_b16 v[56:57], v5 offset:8192
  ds_read_b64_tr_b16 v[58:59], v5 offset:12288
  v_add_f32 v12, v12, v30
  v_cvt_pk_bf16_f32 v47, v30, v31
  v_add_f32 v12, v12, v31
  v_mfma_f32_16x16x32_bf16 v[96:99], v[60:63], v[148:151], v[96:99]
  ds_read_b64_tr_b16 v[60:61], v6 offset:8192
  ds_read_b64_tr_b16 v[62:63], v6 offset:12288
  v_cmp_lt_f32 vcc, s72, v12
  s_cbranch_vccz Lok_13
  s_swappc_b64 s[76:77], s[78:79]
Lok_13:
  v_add_f32 v9, v9, v12
  v_mfma_f32_16x16x32_bf16 v[96:99], v[64:67], v[152:155], v[96:99]
  ds_read_b64_tr_b16 v[64:65], v5 offset:8704
  ds_read_b64_tr_b16 v[66:67], v5 offset:12800
  v_exp_f32 v24, v92
  v_exp_f32 v25, v93
  v_mfma_f32_16x16x32_bf16 v[96:99], v[68:71], v[156:159], v[96:99]
  ds_read_b64_tr_b16 v[68:69], v6 offset:8704
  ds_read_b64_tr_b16 v[70:71], v6 offset:12800
  v_exp_f32 v26, v94
  v_exp_f32 v27, v95
  v_mfma_f32_16x16x32_bf16 v[108:111], v[72:75], v[144:147], v[40:43]
  ds_read_b64_tr_b16 v[72:73], v5 offset:9216
  ds_read_b64_tr_b16 v[74:75], v5 offset:13312
  v_add_f32 v13, v24, v25
  v_cvt_pk_bf16_f32 v48, v24, v25
  v_mfma_f32_16x16x32_bf16 v[108:111], v[76:79], v[148:151], v[108:111]
  ds_read_b64_tr_b16 v[76:77], v6 offset:9216
  ds_read_b64_tr_b16 v[78:79], v6 offset:13312
  v_add_f32 v13, v13, v26
  v_exp_f32 v28, v104
  v_mfma_f32_16x16x32_bf16 v[108:111], v[80:83], v[152:155], v[108:111]
  ds_read_b64_tr_b16 v[80:81], v5 offset:9728
  ds_read_b64_tr_b16 v[82:83], v5 offset:13824
  v_exp_f32 v29, v105
  v_cvt_pk_bf16_f32 v49, v26, v27
  v_mfma_f32_16x16x32_bf16 v[108:111], v[84:87], v[156:159], v[108:111]
  ds_read_b64_tr_b16 v[84:85], v6 offset:9728
  ds_read_b64_tr_b16 v[86:87], v6 offset:13824
  v_add_f32 v13, v13, v27
  v_exp_f32 v30, v106
  v_add_u32 v4, 0xffff8000, v4
  v_add_u32 v5, 0xffff8000, v5
  v_add_u32 v6, 0xffff8000, v6
  v_exp_f32 v31, v107
  v_add_f32 v13, v13, v28
  v_cvt_pk_bf16_f32 v50, v28, v29
  v_add_f32 v13, v13, v29
  v_add_f32 v13, v13, v30
  v_cvt_pk_bf16_f32 v51, v30, v31
  v_add_f32 v13, v13, v31
  v_cmp_lt_f32 vcc, s72, v13
  s_cbranch_vccz Lok_14
  s_swappc_b64 s[76:77], s[80:81]
Lok_14:
  v_add_f32 v10, v10, v13
  s_waitcnt vmcnt(12)
  s_waitcnt lgkmcnt(0)
  s_barrier
  s_setprio 0
  v_mfma_f32_16x16x32_bf16 v[160:163], v[56:59], v[44:47], v[160:163]
  v_exp_f32 v24, v96
  v_exp_f32 v25, v97
  v_mfma_f32_16x16x32_bf16 v[172:175], v[60:63], v[44:47], v[172:175]
  v_exp_f32 v26, v98
  v_mfma_f32_16x16x32_bf16 v[184:187], v[64:67], v[44:47], v[184:187]
  v_exp_f32 v27, v99
  v_mfma_f32_16x16x32_bf16 v[196:199], v[68:71], v[44:47], v[196:199]
  v_add_f32 v14, v24, v25
  v_cvt_pk_bf16_f32 v52, v24, v25
  v_mfma_f32_16x16x32_bf16 v[208:211], v[72:75], v[44:47], v[208:211]
  v_add_f32 v14, v14, v26
  v_mfma_f32_16x16x32_bf16 v[220:223], v[76:79], v[44:47], v[220:223]
  v_exp_f32 v28, v108
  v_mfma_f32_16x16x32_bf16 v[232:235], v[80:83], v[44:47], v[232:235]
  v_exp_f32 v29, v109
  v_cvt_pk_bf16_f32 v53, v26, v27
  v_mfma_f32_16x16x32_bf16 v[244:247], v[84:87], v[44:47], v[244:247]
  v_add_f32 v14, v14, v27
  v_mfma_f32_16x16x32_bf16 v[164:167], v[56:59], v[48:51], v[164:167]
  v_exp_f32 v30, v110
  v_mfma_f32_16x16x32_bf16 v[176:179], v[60:63], v[48:51], v[176:179]
  v_exp_f32 v31, v111
  v_add_f32 v14, v14, v28
  v_mfma_f32_16x16x32_bf16 v[188:191], v[64:67], v[48:51], v[188:191]
  v_cvt_pk_bf16_f32 v54, v28, v29
  v_mfma_f32_16x16x32_bf16 v[200:203], v[68:71], v[48:51], v[200:203]
  v_add_f32 v14, v14, v29
  v_mfma_f32_16x16x32_bf16 v[212:215], v[72:75], v[48:51], v[212:215]
  v_add_f32 v14, v14, v30
  v_cvt_pk_bf16_f32 v55, v30, v31
  v_mfma_f32_16x16x32_bf16 v[224:227], v[76:79], v[48:51], v[224:227]
  v_add_f32 v14, v14, v31
  v_mfma_f32_16x16x32_bf16 v[236:239], v[80:83], v[48:51], v[236:239]
  v_cmp_lt_f32 vcc, s72, v14
  s_cbranch_vccz Lok_15
  s_swappc_b64 s[76:77], s[82:83]
Lok_15:
  v_mfma_f32_16x16x32_bf16 v[248:251], v[84:87], v[48:51], v[248:251]
  v_add_f32 v11, v11, v14
  s_nop 1
  v_mfma_f32_16x16x32_bf16 v[168:171], v[56:59], v[52:55], v[168:171]
  s_add_u32 m0, s63, 0x10000
  s_add_u32 s69, s62, 0x3c000
  buffer_load_dwordx4 v7, s[8:11], s69 offen nt lds
  v_mfma_f32_16x16x32_bf16 v[180:183], v[60:63], v[52:55], v[180:183]
  v_mfma_f32_16x16x32_bf16 v[192:195], v[64:67], v[52:55], v[192:195]
  s_add_u32 m0, s63, 0x12000
  s_add_u32 s69, s62, 0x3c000
  buffer_load_dwordx4 v8, s[12:15], s69 offen nt lds
  v_mfma_f32_16x16x32_bf16 v[204:207], v[68:71], v[52:55], v[204:207]
  v_mfma_f32_16x16x32_bf16 v[216:219], v[72:75], v[52:55], v[216:219]
  s_add_u32 m0, s63, 0x14000
  s_add_u32 s69, s62, 0x3e000
  buffer_load_dwordx4 v7, s[8:11], s69 offen nt lds
  v_mfma_f32_16x16x32_bf16 v[228:231], v[76:79], v[52:55], v[228:231]
  v_mfma_f32_16x16x32_bf16 v[240:243], v[80:83], v[52:55], v[240:243]
  s_add_u32 m0, s63, 0x16000
  s_add_u32 s69, s62, 0x3e000
  buffer_load_dwordx4 v8, s[12:15], s69 offen nt lds
  v_mfma_f32_16x16x32_bf16 v[252:255], v[84:87], v[52:55], v[252:255]
  s_waitcnt vmcnt(12)
  s_waitcnt lgkmcnt(0)
  s_barrier
  s_setprio 3
  ds_read_b128 v[56:59], v4 offset:0
  ds_read_b128 v[60:63], v4 offset:256
  ds_read_b128 v[64:67], v4 offset:512
  ds_read_b128 v[68:71], v4 offset:768
  ds_read_b128 v[72:75], v4 offset:4096
  ds_read_b128 v[76:79], v4 offset:4352
  ds_read_b128 v[80:83], v4 offset:4608
  ds_read_b128 v[84:87], v4 offset:4864
  s_add_u32 m0, s63, 0x0
  s_add_u32 s69, s73, 0x0
  buffer_load_dwordx4 v20, s[20:23], s69 offen  lds
  s_add_u32 m0, s63, 0x2000
  s_add_u32 s69, s73, 0x8000
  buffer_load_dwordx4 v20, s[20:23], s69 offen  lds
  s_add_u32 m0, s63, 0x4000
  s_add_u32 s69, s73, 0x10000
  buffer_load_dwordx4 v20, s[20:23], s69 offen  lds
  s_add_u32 m0, s63, 0x6000
  s_add_u32 s69, s73, 0x18000
  buffer_load_dwordx4 v20, s[20:23], s69 offen  lds
  s_waitcnt lgkmcnt(7)
  v_mfma_f32_16x16x32_bf16 v[88:91], v[56:59], v[112:115], v[32:35]
  s_waitcnt lgkmcnt(6)
  v_mfma_f32_16x16x32_bf16 v[88:91], v[60:63], v[116:119], v[88:91]
  s_waitcnt lgkmcnt(5)
  v_mfma_f32_16x16x32_bf16 v[88:91], v[64:67], v[120:123], v[88:91]
  s_waitcnt lgkmcnt(4)
  v_mfma_f32_16x16x32_bf16 v[88:91], v[68:71], v[124:127], v[88:91]
  s_waitcnt lgkmcnt(3)
  v_mfma_f32_16x16x32_bf16 v[100:103], v[72:75], v[112:115], v[32:35]
  s_waitcnt lgkmcnt(2)
  v_mfma_f32_16x16x32_bf16 v[100:103], v[76:79], v[116:119], v[100:103]
  s_waitcnt lgkmcnt(1)
  v_mfma_f32_16x16x32_bf16 v[100:103], v[80:83], v[120:123], v[100:103]
  s_waitcnt lgkmcnt(0)
  v_mfma_f32_16x16x32_bf16 v[100:103], v[84:87], v[124:127], v[100:103]
  v_mfma_f32_16x16x32_bf16 v[92:95], v[56:59], v[128:131], v[36:39]
  v_exp_f32 v24, v88
  v_exp_f32 v25, v89
  v_mfma_f32_16x16x32_bf16 v[92:95], v[60:63], v[132:135], v[92:95]
  v_exp_f32 v26, v90
  v_exp_f32 v27, v91
  v_mfma_f32_16x16x32_bf16 v[92:95], v[64:67], v[136:139], v[92:95]
  v_add_f32 v12, v24, v25
  v_cvt_pk_bf16_f32 v44, v24, v25
  v_mfma_f32_16x16x32_bf16 v[92:95], v[68:71], v[140:143], v[92:95]
  v_add_f32 v12, v12, v26
  v_exp_f32 v28, v100
  v_mfma_f32_16x16x32_bf16 v[104:107], v[72:75], v[128:131], v[36:39]
  v_exp_f32 v29, v101
  v_cvt_pk_bf16_f32 v45, v26, v27
  v_mfma_f32_16x16x32_bf16 v[104:107], v[76:79], v[132:135], v[104:107]
  v_add_f32 v12, v12, v27
  v_exp_f32 v30, v102
  v_mfma_f32_16x16x32_bf16 v[104:107], v[80:83], v[136:139], v[104:107]
  v_exp_f32 v31, v103
  v_add_f32 v12, v12, v28
  v_mfma_f32_16x16x32_bf16 v[104:107], v[84:87], v[140:143], v[104:107]
  v_cvt_pk_bf16_f32 v46, v28, v29
  v_add_f32 v12, v12, v29
  v_mfma_f32_16x16x32_bf16 v[96:99], v[56:59], v[144:147], v[40:43]
  ds_read_b64_tr_b16 v[56:57], v5 offset:8192
  ds_read_b64_tr_b16 v[58:59], v5 offset:12288
  v_add_f32 v12, v12, v30
  v_cvt_pk_bf16_f32 v47, v30, v31
  v_add_f32 v12, v12, v31
  v_mfma_f32_16x16x32_bf16 v[96:99], v[60:63], v[148:151], v[96:99]
  ds_read_b64_tr_b16 v[60:61], v6 offset:8192
  ds_read_b64_tr_b16 v[62:63], v6 offset:12288
  v_cmp_lt_f32 vcc, s72, v12
  s_cbranch_vccz Lok_16
  s_swappc_b64 s[76:77], s[78:79]
Lok_16:
  v_add_f32 v9, v9, v12
  v_mfma_f32_16x16x32_bf16 v[96:99], v[64:67], v[152:155], v[96:99]
  ds_read_b64_tr_b16 v[64:65], v5 offset:8704
  ds_read_b64_tr_b16 v[66:67], v5 offset:12800
  v_exp_f32 v24, v92
  v_exp_f32 v25, v93
  v_mfma_f32_16x16x32_bf16 v[96:99], v[68:71], v[156:159], v[96:99]
  ds_read_b64_tr_b16 v[68:69], v6 offset:8704
  ds_read_b64_tr_b16 v[70:71], v6 offset:12800
  v_exp_f32 v26, v94
  v_exp_f32 v27, v95
  v_mfma_f32_16x16x32_bf16 v[108:111], v[72:75], v[144:147], v[40:43]
  ds_read_b64_tr_b16 v[72:73], v5 offset:9216
  ds_read_b64_tr_b16 v[74:75], v5 offset:13312
  v_add_f32 v13, v24, v25
  v_cvt_pk_bf16_f32 v48, v24, v25
  v_mfma_f32_16x16x32_bf16 v[108:111], v[76:79], v[148:151], v[108:111]
  ds_read_b64_tr_b16 v[76:77], v6 offset:9216
  ds_read_b64_tr_b16 v[78:79], v6 offset:13312
  v_add_f32 v13, v13, v26
  v_exp_f32 v28, v104
  v_mfma_f32_16x16x32_bf16 v[108:111], v[80:83], v[152:155], v[108:111]
  ds_read_b64_tr_b16 v[80:81], v5 offset:9728
  ds_read_b64_tr_b16 v[82:83], v5 offset:13824
  v_exp_f32 v29, v105
  v_cvt_pk_bf16_f32 v49, v26, v27
  v_mfma_f32_16x16x32_bf16 v[108:111], v[84:87], v[156:159], v[108:111]
  ds_read_b64_tr_b16 v[84:85], v6 offset:9728
  ds_read_b64_tr_b16 v[86:87], v6 offset:13824
  v_add_f32 v13, v13, v27
  v_exp_f32 v30, v106
  v_add_u32 v4, 0x10000, v4
  v_add_u32 v5, 0x10000, v5
  v_add_u32 v6, 0x10000, v6
  v_exp_f32 v31, v107
  v_add_f32 v13, v13, v28
  v_cvt_pk_bf16_f32 v50, v28, v29
  v_add_f32 v13, v13, v29
  v_add_f32 v13, v13, v30
  v_cvt_pk_bf16_f32 v51, v30, v31
  v_add_f32 v13, v13, v31
  v_cmp_lt_f32 vcc, s72, v13
  s_cbranch_vccz Lok_17
  s_swappc_b64 s[76:77], s[80:81]
Lok_17:
  v_add_f32 v10, v10, v13
  s_waitcnt vmcnt(12)
  s_waitcnt lgkmcnt(0)
  s_barrier
  s_setprio 0
  v_mfma_f32_16x16x32_bf16 v[160:163], v[56:59], v[44:47], v[160:163]
  v_exp_f32 v24, v96
  v_exp_f32 v25, v97
  v_mfma_f32_16x16x32_bf16 v[172:175], v[60:63], v[44:47], v[172:175]
  v_exp_f32 v26, v98
  v_mfma_f32_16x16x32_bf16 v[184:187], v[64:67], v[44:47], v[184:187]
  v_exp_f32 v27, v99
  v_mfma_f32_16x16x32_bf16 v[196:199], v[68:71], v[44:47], v[196:199]
  v_add_f32 v14, v24, v25
  v_cvt_pk_bf16_f32 v52, v24, v25
  v_mfma_f32_16x16x32_bf16 v[208:211], v[72:75], v[44:47], v[208:211]
  v_add_f32 v14, v14, v26
  v_mfma_f32_16x16x32_bf16 v[220:223], v[76:79], v[44:47], v[220:223]
  v_exp_f32 v28, v108
  v_mfma_f32_16x16x32_bf16 v[232:235], v[80:83], v[44:47], v[232:235]
  v_exp_f32 v29, v109
  v_cvt_pk_bf16_f32 v53, v26, v27
  v_mfma_f32_16x16x32_bf16 v[244:247], v[84:87], v[44:47], v[244:247]
  v_add_f32 v14, v14, v27
  v_mfma_f32_16x16x32_bf16 v[164:167], v[56:59], v[48:51], v[164:167]
  v_exp_f32 v30, v110
  v_mfma_f32_16x16x32_bf16 v[176:179], v[60:63], v[48:51], v[176:179]
  v_exp_f32 v31, v111
  v_add_f32 v14, v14, v28
  v_mfma_f32_16x16x32_bf16 v[188:191], v[64:67], v[48:51], v[188:191]
  v_cvt_pk_bf16_f32 v54, v28, v29
  v_mfma_f32_16x16x32_bf16 v[200:203], v[68:71], v[48:51], v[200:203]
  v_add_f32 v14, v14, v29
  v_mfma_f32_16x16x32_bf16 v[212:215], v[72:75], v[48:51], v[212:215]
  v_add_f32 v14, v14, v30
  v_cvt_pk_bf16_f32 v55, v30, v31
  v_mfma_f32_16x16x32_bf16 v[224:227], v[76:79], v[48:51], v[224:227]
  v_add_f32 v14, v14, v31
  v_mfma_f32_16x16x32_bf16 v[236:239], v[80:83], v[48:51], v[236:239]
  v_cmp_lt_f32 vcc, s72, v14
  s_cbranch_vccz Lok_18
  s_swappc_b64 s[76:77], s[82:83]
Lok_18:
  v_mfma_f32_16x16x32_bf16 v[248:251], v[84:87], v[48:51], v[248:251]
  v_add_f32 v11, v11, v14
  s_nop 1
  v_mfma_f32_16x16x32_bf16 v[168:171], v[56:59], v[52:55], v[168:171]
  s_add_u32 m0, s63, 0x8000
  s_add_u32 s69, s73, 0x20000
  buffer_load_dwordx4 v20, s[20:23], s69 offen  lds
  v_mfma_f32_16x16x32_bf16 v[180:183], v[60:63], v[52:55], v[180:183]
  v_mfma_f32_16x16x32_bf16 v[192:195], v[64:67], v[52:55], v[192:195]
  s_add_u32 m0, s63, 0xa000
  s_add_u32 s69, s73, 0x28000
  buffer_load_dwordx4 v20, s[20:23], s69 offen  lds
  v_mfma_f32_16x16x32_bf16 v[204:207], v[68:71], v[52:55], v[204:207]
  v_mfma_f32_16x16x32_bf16 v[216:219], v[72:75], v[52:55], v[216:219]
  s_add_u32 m0, s63, 0xc000
  s_add_u32 s69, s73, 0x30000
  buffer_load_dwordx4 v20, s[20:23], s69 offen  lds
  v_mfma_f32_16x16x32_bf16 v[228:231], v[76:79], v[52:55], v[228:231]
  v_mfma_f32_16x16x32_bf16 v[240:243], v[80:83], v[52:55], v[240:243]
  s_add_u32 m0, s63, 0xe000
  s_add_u32 s69, s73, 0x38000
  buffer_load_dwordx4 v20, s[20:23], s69 offen  lds
  v_mfma_f32_16x16x32_bf16 v[252:255], v[84:87], v[52:55], v[252:255]
  s_waitcnt vmcnt(12)
  s_waitcnt lgkmcnt(0)
  s_barrier
  s_setprio 3
  ds_read_b128 v[56:59], v4 offset:0
  ds_read_b128 v[60:63], v4 offset:256
  ds_read_b128 v[64:67], v4 offset:512
  ds_read_b128 v[68:71], v4 offset:768
  ds_read_b128 v[72:75], v4 offset:4096
  ds_read_b128 v[76:79], v4 offset:4352
  ds_read_b128 v[80:83], v4 offset:4608
  ds_read_b128 v[84:87], v4 offset:4864
  s_add_u32 m0, s63, 0x20000
  s_add_u32 s69, s73, 0x40000
  buffer_load_dwordx4 v20, s[20:23], s69 offen  lds
  s_add_u32 m0, s63, 0x22000
  s_add_u32 s69, s73, 0x48000
  buffer_load_dwordx4 v20, s[20:23], s69 offen  lds
  s_add_u32 m0, s63, 0x24000
  s_add_u32 s69, s73, 0x50000
  buffer_load_dwordx4 v20, s[20:23], s69 offen  lds
  s_add_u32 m0, s63, 0x26000
  s_add_u32 s69, s73, 0x58000
  buffer_load_dwordx4 v20, s[20:23], s69 offen  lds
  s_waitcnt lgkmcnt(7)
  v_mfma_f32_16x16x32_bf16 v[88:91], v[56:59], v[112:115], v[32:35]
  s_waitcnt lgkmcnt(6)
  v_mfma_f32_16x16x32_bf16 v[88:91], v[60:63], v[116:119], v[88:91]
  s_waitcnt lgkmcnt(5)
  v_mfma_f32_16x16x32_bf16 v[88:91], v[64:67], v[120:123], v[88:91]
  s_waitcnt lgkmcnt(4)
  v_mfma_f32_16x16x32_bf16 v[88:91], v[68:71], v[124:127], v[88:91]
  s_waitcnt lgkmcnt(3)
  v_mfma_f32_16x16x32_bf16 v[100:103], v[72:75], v[112:115], v[32:35]
  s_waitcnt lgkmcnt(2)
  v_mfma_f32_16x16x32_bf16 v[100:103], v[76:79], v[116:119], v[100:103]
  s_waitcnt lgkmcnt(1)
  v_mfma_f32_16x16x32_bf16 v[100:103], v[80:83], v[120:123], v[100:103]
  s_waitcnt lgkmcnt(0)
  v_mfma_f32_16x16x32_bf16 v[100:103], v[84:87], v[124:127], v[100:103]
  v_mfma_f32_16x16x32_bf16 v[92:95], v[56:59], v[128:131], v[36:39]
  v_exp_f32 v24, v88
  v_exp_f32 v25, v89
  v_mfma_f32_16x16x32_bf16 v[92:95], v[60:63], v[132:135], v[92:95]
  v_exp_f32 v26, v90
  v_exp_f32 v27, v91
  v_mfma_f32_16x16x32_bf16 v[92:95], v[64:67], v[136:139], v[92:95]
  v_add_f32 v12, v24, v25
  v_cvt_pk_bf16_f32 v44, v24, v25
  v_mfma_f32_16x16x32_bf16 v[92:95], v[68:71], v[140:143], v[92:95]
  v_add_f32 v12, v12, v26
  v_exp_f32 v28, v100
  v_mfma_f32_16x16x32_bf16 v[104:107], v[72:75], v[128:131], v[36:39]
  v_exp_f32 v29, v101
  v_cvt_pk_bf16_f32 v45, v26, v27
  v_mfma_f32_16x16x32_bf16 v[104:107], v[76:79], v[132:135], v[104:107]
  v_add_f32 v12, v12, v27
  v_exp_f32 v30, v102
  v_mfma_f32_16x16x32_bf16 v[104:107], v[80:83], v[136:139], v[104:107]
  v_exp_f32 v31, v103
  v_add_f32 v12, v12, v28
  v_mfma_f32_16x16x32_bf16 v[104:107], v[84:87], v[140:143], v[104:107]
  v_cvt_pk_bf16_f32 v46, v28, v29
  v_add_f32 v12, v12, v29
  v_mfma_f32_16x16x32_bf16 v[96:99], v[56:59], v[144:147], v[40:43]
  ds_read_b64_tr_b16 v[56:57], v5 offset:8192
  ds_read_b64_tr_b16 v[58:59], v5 offset:12288
  v_add_f32 v12, v12, v30
  v_cvt_pk_bf16_f32 v47, v30, v31
  v_add_f32 v12, v12, v31
  v_mfma_f32_16x16x32_bf16 v[96:99], v[60:63], v[148:151], v[96:99]
  ds_read_b64_tr_b16 v[60:61], v6 offset:8192
  ds_read_b64_tr_b16 v[62:63], v6 offset:12288
  v_cmp_lt_f32 vcc, s72, v12
  s_cbranch_vccz Lok_19
  s_swappc_b64 s[76:77], s[78:79]
Lok_19:
  v_add_f32 v9, v9, v12
  v_mfma_f32_16x16x32_bf16 v[96:99], v[64:67], v[152:155], v[96:99]
  ds_read_b64_tr_b16 v[64:65], v5 offset:8704
  ds_read_b64_tr_b16 v[66:67], v5 offset:12800
  v_exp_f32 v24, v92
  v_exp_f32 v25, v93
  v_mfma_f32_16x16x32_bf16 v[96:99], v[68:71], v[156:159], v[96:99]
  ds_read_b64_tr_b16 v[68:69], v6 offset:8704
  ds_read_b64_tr_b16 v[70:71], v6 offset:12800
  v_exp_f32 v26, v94
  v_exp_f32 v27, v95
  v_mfma_f32_16x16x32_bf16 v[108:111], v[72:75], v[144:147], v[40:43]
  ds_read_b64_tr_b16 v[72:73], v5 offset:9216
  ds_read_b64_tr_b16 v[74:75], v5 offset:13312
  v_add_f32 v13, v24, v25
  v_cvt_pk_bf16_f32 v48, v24, v25
  v_mfma_f32_16x16x32_bf16 v[108:111], v[76:79], v[148:151], v[108:111]
  ds_read_b64_tr_b16 v[76:77], v6 offset:9216
  ds_read_b64_tr_b16 v[78:79], v6 offset:13312
  v_add_f32 v13, v13, v26
  v_exp_f32 v28, v104
  v_mfma_f32_16x16x32_bf16 v[108:111], v[80:83], v[152:155], v[108:111]
  ds_read_b64_tr_b16 v[80:81], v5 offset:9728
  ds_read_b64_tr_b16 v[82:83], v5 offset:13824
  v_exp_f32 v29, v105
  v_cvt_pk_bf16_f32 v49, v26, v27
  v_mfma_f32_16x16x32_bf16 v[108:111], v[84:87], v[156:159], v[108:111]
  ds_read_b64_tr_b16 v[84:85], v6 offset:9728
  ds_read_b64_tr_b16 v[86:87], v6 offset:13824
  v_add_f32 v13, v13, v27
  v_exp_f32 v30, v106
  v_exp_f32 v31, v107
  v_add_f32 v13, v13, v28
  v_cvt_pk_bf16_f32 v50, v28, v29
  v_add_f32 v13, v13, v29
  v_add_f32 v13, v13, v30
  v_cvt_pk_bf16_f32 v51, v30, v31
  v_add_f32 v13, v13, v31
  v_cmp_lt_f32 vcc, s72, v13
  s_cbranch_vccz Lok_20
  s_swappc_b64 s[76:77], s[80:81]
Lok_20:
  v_add_f32 v10, v10, v13
  s_waitcnt vmcnt(12)
  s_waitcnt lgkmcnt(0)
  s_barrier
  s_setprio 0
  v_mfma_f32_16x16x32_bf16 v[160:163], v[56:59], v[44:47], v[160:163]
  v_exp_f32 v24, v96
  v_exp_f32 v25, v97
  v_mfma_f32_16x16x32_bf16 v[172:175], v[60:63], v[44:47], v[172:175]
  v_exp_f32 v26, v98
  v_mfma_f32_16x16x32_bf16 v[184:187], v[64:67], v[44:47], v[184:187]
  v_exp_f32 v27, v99
  v_mfma_f32_16x16x32_bf16 v[196:199], v[68:71], v[44:47], v[196:199]
  v_add_f32 v14, v24, v25
  v_cvt_pk_bf16_f32 v52, v24, v25
  v_mfma_f32_16x16x32_bf16 v[208:211], v[72:75], v[44:47], v[208:211]
  v_add_f32 v14, v14, v26
  v_mfma_f32_16x16x32_bf16 v[220:223], v[76:79], v[44:47], v[220:223]
  v_exp_f32 v28, v108
  v_mfma_f32_16x16x32_bf16 v[232:235], v[80:83], v[44:47], v[232:235]
  v_exp_f32 v29, v109
  v_cvt_pk_bf16_f32 v53, v26, v27
  v_mfma_f32_16x16x32_bf16 v[244:247], v[84:87], v[44:47], v[244:247]
  v_add_f32 v14, v14, v27
  v_mfma_f32_16x16x32_bf16 v[164:167], v[56:59], v[48:51], v[164:167]
  v_exp_f32 v30, v110
  v_mfma_f32_16x16x32_bf16 v[176:179], v[60:63], v[48:51], v[176:179]
  v_exp_f32 v31, v111
  v_add_f32 v14, v14, v28
  v_mfma_f32_16x16x32_bf16 v[188:191], v[64:67], v[48:51], v[188:191]
  v_cvt_pk_bf16_f32 v54, v28, v29
  v_mfma_f32_16x16x32_bf16 v[200:203], v[68:71], v[48:51], v[200:203]
  v_add_f32 v14, v14, v29
  v_mfma_f32_16x16x32_bf16 v[212:215], v[72:75], v[48:51], v[212:215]
  v_add_f32 v14, v14, v30
  v_cvt_pk_bf16_f32 v55, v30, v31
  v_mfma_f32_16x16x32_bf16 v[224:227], v[76:79], v[48:51], v[224:227]
  v_add_f32 v14, v14, v31
  v_mfma_f32_16x16x32_bf16 v[236:239], v[80:83], v[48:51], v[236:239]
  v_cmp_lt_f32 vcc, s72, v14
  s_cbranch_vccz Lok_21
  s_swappc_b64 s[76:77], s[82:83]
Lok_21:
  v_mfma_f32_16x16x32_bf16 v[248:251], v[84:87], v[48:51], v[248:251]
  v_add_f32 v11, v11, v14
  s_nop 1
  v_mfma_f32_16x16x32_bf16 v[168:171], v[56:59], v[52:55], v[168:171]
  v_lshlrev_b32 v21, 7, v1
  s_lshl_b32 s69, s2, 3
  s_add_u32 s69, s69, s56
  s_mul_i32 s69, s69, 3584
  s_bfm_b64 exec, 27, 0
  buffer_load_dword v17, v21, s[32:35], s69 offen offset:0
  s_mov_b64 exec, -1
  s_nop 3
  s_nop 0
  v_mfma_f32_16x16x32_bf16 v[180:183], v[60:63], v[52:55], v[180:183]
  s_add_u32 m0, s63, 0x18000
  s_add_u32 s69, s73, 0x60000
  buffer_load_dwordx4 v20, s[20:23], s69 offen  lds
  v_mfma_f32_16x16x32_bf16 v[192:195], v[64:67], v[52:55], v[192:195]
  v_mfma_f32_16x16x32_bf16 v[204:207], v[68:71], v[52:55], v[204:207]
  s_add_u32 m0, s63, 0x1a000
  s_add_u32 s69, s73, 0x68000
  buffer_load_dwordx4 v20, s[20:23], s69 offen  lds
  v_mfma_f32_16x16x32_bf16 v[216:219], v[72:75], v[52:55], v[216:219]
  s_add_u32 m0, s63, 0x1c000
  s_add_u32 s69, s73, 0x70000
  buffer_load_dwordx4 v20, s[20:23], s69 offen  lds
  v_mfma_f32_16x16x32_bf16 v[228:231], v[76:79], v[52:55], v[228:231]
  v_mfma_f32_16x16x32_bf16 v[240:243], v[80:83], v[52:55], v[240:243]
  s_add_u32 m0, s63, 0x1e000
  s_add_u32 s69, s73, 0x78000
  buffer_load_dwordx4 v20, s[20:23], s69 offen  lds
  v_mfma_f32_16x16x32_bf16 v[252:255], v[84:87], v[52:55], v[252:255]
  s_waitcnt vmcnt(5)
  s_waitcnt lgkmcnt(0)
  s_barrier
  s_setprio 0
  s_bfe_u32 s68, s56, 0x10001
  s_lshl_b32 s68, s68, 14
  s_add_u32 s68, s68, 98304
  v_subrev_u32 v5, s68, v5
  s_and_b32 s68, s56, 1
  s_lshl_b32 s68, s68, 5
  v_xor_b32 v5, s68, v5
  s_lshr_b32 s68, s56, 1
  s_lshl_b32 s68, s68, 9
  v_add_u32 v5, s68, v5
  v_add_u32 v6, 98304, v5
  ds_read_b64_tr_b16 v[112:113], v5 offset:0
  ds_read_b64_tr_b16 v[114:115], v5 offset:4096
  ds_read_b64_tr_b16 v[116:117], v5 offset:8192
  ds_read_b64_tr_b16 v[118:119], v5 offset:12288
  ds_read_b64_tr_b16 v[120:121], v5 offset:16384
  ds_read_b64_tr_b16 v[122:123], v5 offset:20480
  ds_read_b64_tr_b16 v[124:125], v5 offset:24576
  ds_read_b64_tr_b16 v[126:127], v5 offset:28672
  ds_read_b64_tr_b16 v[128:129], v5 offset:32768
  ds_read_b64_tr_b16 v[130:131], v5 offset:36864
  ds_read_b64_tr_b16 v[132:133], v5 offset:40960
  ds_read_b64_tr_b16 v[134:135], v5 offset:45056
  ds_read_b64_tr_b16 v[136:137], v5 offset:49152
  ds_read_b64_tr_b16 v[138:139], v5 offset:53248
  ds_read_b64_tr_b16 v[140:141], v5 offset:57344
  ds_read_b64_tr_b16 v[142:143], v5 offset:61440
  ds_read_b64_tr_b16 v[144:145], v6 offset:32768
  ds_read_b64_tr_b16 v[146:147], v6 offset:36864
  ds_read_b64_tr_b16 v[148:149], v6 offset:40960
  ds_read_b64_tr_b16 v[150:151], v6 offset:45056
  ds_read_b64_tr_b16 v[152:153], v6 offset:49152
  ds_read_b64_tr_b16 v[154:155], v6 offset:53248
  ds_read_b64_tr_b16 v[156:157], v6 offset:57344
  ds_read_b64_tr_b16 v[158:159], v6 offset:61440
  v_mov_b32 v30, v9
  v_mov_b32 v31, v9
  s_nop 1
  v_permlane16_swap_b32 v30, v31
  s_nop 1
  v_add_f32 v30, v30, v31
  v_mov_b32 v31, v30
  s_nop 1
  v_permlane32_swap_b32 v30, v31
  s_nop 1
  v_add_f32 v9, v30, v31
  v_mov_b32 v30, v10
  v_mov_b32 v31, v10
  s_nop 1
  v_permlane16_swap_b32 v30, v31
  s_nop 1
  v_add_f32 v30, v30, v31
  v_mov_b32 v31, v30
  s_nop 1
  v_permlane32_swap_b32 v30, v31
  s_nop 1
  v_add_f32 v10, v30, v31
  v_mov_b32 v30, v11
  v_mov_b32 v31, v11
  s_nop 1
  v_permlane16_swap_b32 v30, v31
  s_nop 1
  v_add_f32 v30, v30, v31
  v_mov_b32 v31, v30
  s_nop 1
  v_permlane32_swap_b32 v30, v31
  s_nop 1
  v_add_f32 v11, v30, v31
  s_mul_i32 s66, s56, 1536
  s_add_u32 s66, s66, 65536
  v_lshlrev_b32 v27, 2, v1
  v_add_u32 v26, s66, v27
  ds_write_b32 v26, v32 offset:0
  ds_write_b32 v26, v9 offset:768
  ds_write_b32 v26, v36 offset:256
  ds_write_b32 v26, v10 offset:1024
  ds_write_b32 v26, v40 offset:512
  ds_write_b32 v26, v11 offset:1280
  s_waitcnt lgkmcnt(0)
  s_barrier
  s_and_b32 s66, s56, 1
  s_mul_i32 s66, s66, 1536
  s_add_u32 s66, s66, 65536
  v_add_u32 v26, s66, v27
  ds_read_b32 v88, v26 offset:0
  ds_read_b32 v89, v26 offset:256
  ds_read_b32 v90, v26 offset:512
  ds_read_b32 v91, v26 offset:768
  ds_read_b32 v92, v26 offset:1024
  ds_read_b32 v93, v26 offset:1280
  ds_read_b32 v94, v26 offset:3072
  ds_read_b32 v95, v26 offset:3328
  ds_read_b32 v96, v26 offset:3584
  ds_read_b32 v97, v26 offset:3840
  ds_read_b32 v98, v26 offset:4096
  ds_read_b32 v99, v26 offset:4352
  ds_read_b32 v100, v26 offset:6144
  ds_read_b32 v101, v26 offset:6400
  ds_read_b32 v102, v26 offset:6656
  ds_read_b32 v103, v26 offset:6912
  ds_read_b32 v104, v26 offset:7168
  ds_read_b32 v105, v26 offset:7424
  ds_read_b32 v106, v26 offset:9216
  ds_read_b32 v107, v26 offset:9472
  ds_read_b32 v108, v26 offset:9728
  ds_read_b32 v109, v26 offset:9984
  ds_read_b32 v110, v26 offset:10240
  ds_read_b32 v111, v26 offset:10496
  s_mov_b32 s66, 24576
  s_cmp_eq_u32 s57, 1
  s_cselect_b32 s66, 36864, s66
  s_cmp_eq_u32 s57, 2
  s_cselect_b32 s66, 0, s66
  s_cmp_eq_u32 s57, 3
  s_cselect_b32 s66, 12288, s66
  s_add_u32 s66, s66, 0
  v_add_u32 v7, s66, v0
  s_mov_b32 s66, 49152
  s_cmp_eq_u32 s57, 1
  s_cselect_b32 s66, 131072, s66
  s_cmp_eq_u32 s57, 2
  s_cselect_b32 s66, 143360, s66
  s_cmp_eq_u32 s57, 3
  s_cselect_b32 s66, 81920, s66
  s_add_u32 s66, s66, 3072
  v_add_u32 v8, s66, v0
  s_mov_b32 s66, 143360
  s_cmp_eq_u32 s57, 1
  s_cselect_b32 s66, 81920, s66
  s_cmp_eq_u32 s57, 2
  s_cselect_b32 s66, 49152, s66
  s_cmp_eq_u32 s57, 3
  s_cselect_b32 s66, 131072, s66
  s_add_u32 s66, s66, 6144
  v_add_u32 v12, s66, v0
  s_mov_b32 s66, 0
  s_cmp_eq_u32 s57, 1
  s_cselect_b32 s66, 12288, s66
  s_cmp_eq_u32 s57, 2
  s_cselect_b32 s66, 24576, s66
  s_cmp_eq_u32 s57, 3
  s_cselect_b32 s66, 36864, s66
  v_add_u32 v4, s66, v0
  s_waitcnt lgkmcnt(0)
  v_min3_f32 v24, v88, v94, v100
  v_min_f32 v24, v24, v106
  v_sub_f32 v88, v24, v88
  v_sub_f32 v94, v24, v94
  v_sub_f32 v100, v24, v100
  v_sub_f32 v106, v24, v106
  v_sub_f32 v44, v24, v32
  v_exp_f32 v88, v88
  v_exp_f32 v94, v94
  v_exp_f32 v100, v100
  v_exp_f32 v106, v106
  v_exp_f32 v44, v44
  v_mul_f32 v52, v88, v91
  v_fmac_f32 v52, v94, v97
  v_fmac_f32 v52, v100, v103
  v_fmac_f32 v52, v106, v109
  v_rcp_f32 v25, v52
  v_log_f32 v52, v52
  s_nop 0
  v_mul_f32 v44, v44, v25
  v_sub_f32 v52, v52, v24
  v_min3_f32 v24, v89, v95, v101
  v_min_f32 v24, v24, v107
  v_sub_f32 v89, v24, v89
  v_sub_f32 v95, v24, v95
  v_sub_f32 v101, v24, v101
  v_sub_f32 v107, v24, v107
  v_sub_f32 v46, v24, v36
  v_exp_f32 v89, v89
  v_exp_f32 v95, v95
  v_exp_f32 v101, v101
  v_exp_f32 v107, v107
  v_exp_f32 v46, v46
  v_mul_f32 v53, v89, v92
  v_fmac_f32 v53, v95, v98
  v_fmac_f32 v53, v101, v104
  v_fmac_f32 v53, v107, v110
  v_rcp_f32 v25, v53
  v_log_f32 v53, v53
  s_nop 0
  v_mul_f32 v46, v46, v25
  v_sub_f32 v53, v53, v24
  v_min3_f32 v24, v90, v96, v102
  v_min_f32 v24, v24, v108
  v_sub_f32 v90, v24, v90
  v_sub_f32 v96, v24, v96
  v_sub_f32 v102, v24, v102
  v_sub_f32 v108, v24, v108
  v_sub_f32 v48, v24, v40
  v_exp_f32 v90, v90
  v_exp_f32 v96, v96
  v_exp_f32 v102, v102
  v_exp_f32 v108, v108
  v_exp_f32 v48, v48
  v_mul_f32 v54, v90, v93
  v_fmac_f32 v54, v96, v99
  v_fmac_f32 v54, v102, v105
  v_fmac_f32 v54, v108, v111
  v_rcp_f32 v25, v54
  v_log_f32 v54, v54
  s_nop 0
  v_mul_f32 v48, v48, v25
  v_sub_f32 v54, v54, v24
  s_mov_b32 s69, 0xffff0000
  s_bitcmp1_b32 s56, 1
  s_cbranch_scc1 Lc_22
  v_pk_mul_f32 v[184:185], v[184:185], v[44:45] op_sel_hi:[1,0]
  v_pk_mul_f32 v[186:187], v[186:187], v[44:45] op_sel_hi:[1,0]
  v_cvt_pk_bf16_f32 v68, v184, v185
  v_cvt_pk_bf16_f32 v69, v186, v187
  v_pk_mul_f32 v[196:197], v[196:197], v[44:45] op_sel_hi:[1,0]
  v_pk_mul_f32 v[198:199], v[198:199], v[44:45] op_sel_hi:[1,0]
  v_cvt_pk_bf16_f32 v70, v196, v197
  v_cvt_pk_bf16_f32 v71, v198, v199
  ds_write_b128 v7, v[68:71] offset:0
  v_pk_mul_f32 v[188:189], v[188:189], v[46:47] op_sel_hi:[1,0]
  v_pk_mul_f32 v[190:191], v[190:191], v[46:47] op_sel_hi:[1,0]
  v_cvt_pk_bf16_f32 v72, v188, v189
  v_cvt_pk_bf16_f32 v73, v190, v191
  v_pk_mul_f32 v[200:201], v[200:201], v[46:47] op_sel_hi:[1,0]
  v_pk_mul_f32 v[202:203], v[202:203], v[46:47] op_sel_hi:[1,0]
  v_cvt_pk_bf16_f32 v74, v200, v201
  v_cvt_pk_bf16_f32 v75, v202, v203
  ds_write_b128 v7, v[72:75] offset:1024
  v_pk_mul_f32 v[192:193], v[192:193], v[48:49] op_sel_hi:[1,0]
  v_pk_mul_f32 v[194:195], v[194:195], v[48:49] op_sel_hi:[1,0]
  v_cvt_pk_bf16_f32 v76, v192, v193
  v_cvt_pk_bf16_f32 v77, v194, v195
  v_pk_mul_f32 v[204:205], v[204:205], v[48:49] op_sel_hi:[1,0]
  v_pk_mul_f32 v[206:207], v[206:207], v[48:49] op_sel_hi:[1,0]
  v_cvt_pk_bf16_f32 v78, v204, v205
  v_cvt_pk_bf16_f32 v79, v206, v207
  ds_write_b128 v7, v[76:79] offset:2048
  v_pk_mul_f32 v[208:209], v[208:209], v[44:45] op_sel_hi:[1,0]
  v_pk_mul_f32 v[210:211], v[210:211], v[44:45] op_sel_hi:[1,0]
  v_cvt_pk_bf16_f32 v80, v208, v209
  v_cvt_pk_bf16_f32 v81, v210, v211
  v_pk_mul_f32 v[220:221], v[220:221], v[44:45] op_sel_hi:[1,0]
  v_pk_mul_f32 v[222:223], v[222:223], v[44:45] op_sel_hi:[1,0]
  v_cvt_pk_bf16_f32 v82, v220, v221
  v_cvt_pk_bf16_f32 v83, v222, v223
  ds_write_b128 v8, v[80:83] offset:0
  v_pk_mul_f32 v[212:213], v[212:213], v[46:47] op_sel_hi:[1,0]
  v_pk_mul_f32 v[214:215], v[214:215], v[46:47] op_sel_hi:[1,0]
  v_cvt_pk_bf16_f32 v68, v212, v213
  v_cvt_pk_bf16_f32 v69, v214, v215
  v_pk_mul_f32 v[224:225], v[224:225], v[46:47] op_sel_hi:[1,0]
  v_pk_mul_f32 v[226:227], v[226:227], v[46:47] op_sel_hi:[1,0]
  v_cvt_pk_bf16_f32 v70, v224, v225
  v_cvt_pk_bf16_f32 v71, v226, v227
  ds_write_b128 v8, v[68:71] offset:1024
  v_pk_mul_f32 v[216:217], v[216:217], v[48:49] op_sel_hi:[1,0]
  v_pk_mul_f32 v[218:219], v[218:219], v[48:49] op_sel_hi:[1,0]
  v_cvt_pk_bf16_f32 v72, v216, v217
  v_cvt_pk_bf16_f32 v73, v218, v219
  v_pk_mul_f32 v[228:229], v[228:229], v[48:49] op_sel_hi:[1,0]
  v_pk_mul_f32 v[230:231], v[230:231], v[48:49] op_sel_hi:[1,0]
  v_cvt_pk_bf16_f32 v74, v228, v229
  v_cvt_pk_bf16_f32 v75, v230, v231
  ds_write_b128 v8, v[72:75] offset:2048
  v_pk_mul_f32 v[232:233], v[232:233], v[44:45] op_sel_hi:[1,0]
  v_pk_mul_f32 v[234:235], v[234:235], v[44:45] op_sel_hi:[1,0]
  v_cvt_pk_bf16_f32 v76, v232, v233
  v_cvt_pk_bf16_f32 v77, v234, v235
  v_pk_mul_f32 v[244:245], v[244:245], v[44:45] op_sel_hi:[1,0]
  v_pk_mul_f32 v[246:247], v[246:247], v[44:45] op_sel_hi:[1,0]
  v_cvt_pk_bf16_f32 v78, v244, v245
  v_cvt_pk_bf16_f32 v79, v246, v247
  ds_write_b128 v12, v[76:79] offset:0
  v_pk_mul_f32 v[236:237], v[236:237], v[46:47] op_sel_hi:[1,0]
  v_pk_mul_f32 v[238:239], v[238:239], v[46:47] op_sel_hi:[1,0]
  v_cvt_pk_bf16_f32 v80, v236, v237
  v_cvt_pk_bf16_f32 v81, v238, v239
  v_pk_mul_f32 v[248:249], v[248:249], v[46:47] op_sel_hi:[1,0]
  v_pk_mul_f32 v[250:251], v[250:251], v[46:47] op_sel_hi:[1,0]
  v_cvt_pk_bf16_f32 v82, v248, v249
  v_cvt_pk_bf16_f32 v83, v250, v251
  ds_write_b128 v12, v[80:83] offset:1024
  v_pk_mul_f32 v[240:241], v[240:241], v[48:49] op_sel_hi:[1,0]
  v_pk_mul_f32 v[242:243], v[242:243], v[48:49] op_sel_hi:[1,0]
  v_cvt_pk_bf16_f32 v68, v240, v241
  v_cvt_pk_bf16_f32 v69, v242, v243
  v_pk_mul_f32 v[252:253], v[252:253], v[48:49] op_sel_hi:[1,0]
  v_pk_mul_f32 v[254:255], v[254:255], v[48:49] op_sel_hi:[1,0]
  v_cvt_pk_bf16_f32 v70, v252, v253
  v_cvt_pk_bf16_f32 v71, v254, v255
  ds_write_b128 v12, v[68:71] offset:2048
  v_pk_mul_f32 v[160:161], v[160:161], v[44:45] op_sel_hi:[1,0]
  v_pk_mul_f32 v[162:163], v[162:163], v[44:45] op_sel_hi:[1,0]
  v_pk_mul_f32 v[172:173], v[172:173], v[44:45] op_sel_hi:[1,0]
  v_pk_mul_f32 v[174:175], v[174:175], v[44:45] op_sel_hi:[1,0]
  v_pk_mul_f32 v[164:165], v[164:165], v[46:47] op_sel_hi:[1,0]
  v_pk_mul_f32 v[166:167], v[166:167], v[46:47] op_sel_hi:[1,0]
  v_pk_mul_f32 v[176:177], v[176:177], v[46:47] op_sel_hi:[1,0]
  v_pk_mul_f32 v[178:179], v[178:179], v[46:47] op_sel_hi:[1,0]
  v_pk_mul_f32 v[168:169], v[168:169], v[48:49] op_sel_hi:[1,0]
  v_pk_mul_f32 v[170:171], v[170:171], v[48:49] op_sel_hi:[1,0]
  v_pk_mul_f32 v[180:181], v[180:181], v[48:49] op_sel_hi:[1,0]
  v_pk_mul_f32 v[182:183], v[182:183], v[48:49] op_sel_hi:[1,0]
  s_waitcnt lgkmcnt(0)
  s_barrier
  s_setprio 0
  ds_read_b128 v[88:91], v4 offset:0
  ds_read_b128 v[92:95], v4 offset:1024
  ds_read_b128 v[96:99], v4 offset:2048
  ds_read_b128 v[100:103], v4 offset:3072
  ds_read_b128 v[104:107], v4 offset:4096
  ds_read_b128 v[108:111], v4 offset:5120
  ds_read_b128 v[32:35], v4 offset:6144
  ds_read_b128 v[36:39], v4 offset:7168
  ds_read_b128 v[40:43], v4 offset:8192
  s_waitcnt lgkmcnt(6)
  v_lshlrev_b32 v24, 16, v88
  v_and_b32 v25, s69, v88
  v_pk_add_f32 v[160:161], v[160:161], v[24:25]
  v_lshlrev_b32 v26, 16, v89
  v_and_b32 v27, s69, v89
  v_pk_add_f32 v[162:163], v[162:163], v[26:27]
  v_lshlrev_b32 v24, 16, v90
  v_and_b32 v25, s69, v90
  v_pk_add_f32 v[172:173], v[172:173], v[24:25]
  v_lshlrev_b32 v26, 16, v91
  v_and_b32 v27, s69, v91
  v_pk_add_f32 v[174:175], v[174:175], v[26:27]
  v_lshlrev_b32 v24, 16, v92
  v_and_b32 v25, s69, v92
  v_pk_add_f32 v[164:165], v[164:165], v[24:25]
  v_lshlrev_b32 v26, 16, v93
  v_and_b32 v27, s69, v93
  v_pk_add_f32 v[166:167], v[166:167], v[26:27]
  v_lshlrev_b32 v24, 16, v94
  v_and_b32 v25, s69, v94
  v_pk_add_f32 v[176:177], v[176:177], v[24:25]
  v_lshlrev_b32 v26, 16, v95
  v_and_b32 v27, s69, v95
  v_pk_add_f32 v[178:179], v[178:179], v[26:27]
  v_lshlrev_b32 v24, 16, v96
  v_and_b32 v25, s69, v96
  v_pk_add_f32 v[168:169], v[168:169], v[24:25]
  v_lshlrev_b32 v26, 16, v97
  v_and_b32 v27, s69, v97
  v_pk_add_f32 v[170:171], v[170:171], v[26:27]
  v_lshlrev_b32 v24, 16, v98
  v_and_b32 v25, s69, v98
  v_pk_add_f32 v[180:181], v[180:181], v[24:25]
  v_lshlrev_b32 v26, 16, v99
  v_and_b32 v27, s69, v99
  v_pk_add_f32 v[182:183], v[182:183], v[26:27]
  s_waitcnt lgkmcnt(3)
  v_lshlrev_b32 v24, 16, v100
  v_and_b32 v25, s69, v100
  v_pk_add_f32 v[160:161], v[160:161], v[24:25]
  v_lshlrev_b32 v26, 16, v101
  v_and_b32 v27, s69, v101
  v_pk_add_f32 v[162:163], v[162:163], v[26:27]
  v_lshlrev_b32 v24, 16, v102
  v_and_b32 v25, s69, v102
  v_pk_add_f32 v[172:173], v[172:173], v[24:25]
  v_lshlrev_b32 v26, 16, v103
  v_and_b32 v27, s69, v103
  v_pk_add_f32 v[174:175], v[174:175], v[26:27]
  v_lshlrev_b32 v24, 16, v104
  v_and_b32 v25, s69, v104
  v_pk_add_f32 v[164:165], v[164:165], v[24:25]
  v_lshlrev_b32 v26, 16, v105
  v_and_b32 v27, s69, v105
  v_pk_add_f32 v[166:167], v[166:167], v[26:27]
  v_lshlrev_b32 v24, 16, v106
  v_and_b32 v25, s69, v106
  v_pk_add_f32 v[176:177], v[176:177], v[24:25]
  v_lshlrev_b32 v26, 16, v107
  v_and_b32 v27, s69, v107
  v_pk_add_f32 v[178:179], v[178:179], v[26:27]
  v_lshlrev_b32 v24, 16, v108
  v_and_b32 v25, s69, v108
  v_pk_add_f32 v[168:169], v[168:169], v[24:25]
  v_lshlrev_b32 v26, 16, v109
  v_and_b32 v27, s69, v109
  v_pk_add_f32 v[170:171], v[170:171], v[26:27]
  v_lshlrev_b32 v24, 16, v110
  v_and_b32 v25, s69, v110
  v_pk_add_f32 v[180:181], v[180:181], v[24:25]
  v_lshlrev_b32 v26, 16, v111
  v_and_b32 v27, s69, v111
  v_pk_add_f32 v[182:183], v[182:183], v[26:27]
  s_waitcnt lgkmcnt(0)
  v_lshlrev_b32 v24, 16, v32
  v_and_b32 v25, s69, v32
  v_pk_add_f32 v[160:161], v[160:161], v[24:25]
  v_lshlrev_b32 v26, 16, v33
  v_and_b32 v27, s69, v33
  v_pk_add_f32 v[162:163], v[162:163], v[26:27]
  v_lshlrev_b32 v24, 16, v34
  v_and_b32 v25, s69, v34
  v_pk_add_f32 v[172:173], v[172:173], v[24:25]
  v_lshlrev_b32 v26, 16, v35
  v_and_b32 v27, s69, v35
  v_pk_add_f32 v[174:175], v[174:175], v[26:27]
  v_lshlrev_b32 v24, 16, v36
  v_and_b32 v25, s69, v36
  v_pk_add_f32 v[164:165], v[164:165], v[24:25]
  v_lshlrev_b32 v26, 16, v37
  v_and_b32 v27, s69, v37
  v_pk_add_f32 v[166:167], v[166:167], v[26:27]
  v_lshlrev_b32 v24, 16, v38
  v_and_b32 v25, s69, v38
  v_pk_add_f32 v[176:177], v[176:177], v[24:25]
  v_lshlrev_b32 v26, 16, v39
  v_and_b32 v27, s69, v39
  v_pk_add_f32 v[178:179], v[178:179], v[26:27]
  v_lshlrev_b32 v24, 16, v40
  v_and_b32 v25, s69, v40
  v_pk_add_f32 v[168:169], v[168:169], v[24:25]
  v_lshlrev_b32 v26, 16, v41
  v_and_b32 v27, s69, v41
  v_pk_add_f32 v[170:171], v[170:171], v[26:27]
  v_lshlrev_b32 v24, 16, v42
  v_and_b32 v25, s69, v42
  v_pk_add_f32 v[180:181], v[180:181], v[24:25]
  v_lshlrev_b32 v26, 16, v43
  v_and_b32 v27, s69, v43
  v_pk_add_f32 v[182:183], v[182:183], v[26:27]
  v_cvt_pk_bf16_f32 v56, v160, v161
  v_cvt_pk_bf16_f32 v57, v162, v163
  v_cvt_pk_bf16_f32 v58, v172, v173
  v_cvt_pk_bf16_f32 v59, v174, v175
  v_cvt_pk_bf16_f32 v60, v164, v165
  v_cvt_pk_bf16_f32 v61, v166, v167
  v_cvt_pk_bf16_f32 v62, v176, v177
  v_cvt_pk_bf16_f32 v63, v178, v179
  v_cvt_pk_bf16_f32 v64, v168, v169
  v_cvt_pk_bf16_f32 v65, v170, v171
  v_cvt_pk_bf16_f32 v66, v180, v181
  v_cvt_pk_bf16_f32 v67, v182, v183
  s_branch L_tail
Lc_22:
  v_pk_mul_f32 v[160:161], v[160:161], v[44:45] op_sel_hi:[1,0]
  v_pk_mul_f32 v[162:163], v[162:163], v[44:45] op_sel_hi:[1,0]
  v_cvt_pk_bf16_f32 v68, v160, v161
  v_cvt_pk_bf16_f32 v69, v162, v163
  v_pk_mul_f32 v[172:173], v[172:173], v[44:45] op_sel_hi:[1,0]
  v_pk_mul_f32 v[174:175], v[174:175], v[44:45] op_sel_hi:[1,0]
  v_cvt_pk_bf16_f32 v70, v172, v173
  v_cvt_pk_bf16_f32 v71, v174, v175
  ds_write_b128 v7, v[68:71] offset:0
  v_pk_mul_f32 v[164:165], v[164:165], v[46:47] op_sel_hi:[1,0]
  v_pk_mul_f32 v[166:167], v[166:167], v[46:47] op_sel_hi:[1,0]
  v_cvt_pk_bf16_f32 v72, v164, v165
  v_cvt_pk_bf16_f32 v73, v166, v167
  v_pk_mul_f32 v[176:177], v[176:177], v[46:47] op_sel_hi:[1,0]
  v_pk_mul_f32 v[178:179], v[178:179], v[46:47] op_sel_hi:[1,0]
  v_cvt_pk_bf16_f32 v74, v176, v177
  v_cvt_pk_bf16_f32 v75, v178, v179
  ds_write_b128 v7, v[72:75] offset:1024
  v_pk_mul_f32 v[168:169], v[168:169], v[48:49] op_sel_hi:[1,0]
  v_pk_mul_f32 v[170:171], v[170:171], v[48:49] op_sel_hi:[1,0]
  v_cvt_pk_bf16_f32 v76, v168, v169
  v_cvt_pk_bf16_f32 v77, v170, v171
  v_pk_mul_f32 v[180:181], v[180:181], v[48:49] op_sel_hi:[1,0]
  v_pk_mul_f32 v[182:183], v[182:183], v[48:49] op_sel_hi:[1,0]
  v_cvt_pk_bf16_f32 v78, v180, v181
  v_cvt_pk_bf16_f32 v79, v182, v183
  ds_write_b128 v7, v[76:79] offset:2048
  v_pk_mul_f32 v[208:209], v[208:209], v[44:45] op_sel_hi:[1,0]
  v_pk_mul_f32 v[210:211], v[210:211], v[44:45] op_sel_hi:[1,0]
  v_cvt_pk_bf16_f32 v80, v208, v209
  v_cvt_pk_bf16_f32 v81, v210, v211
  v_pk_mul_f32 v[220:221], v[220:221], v[44:45] op_sel_hi:[1,0]
  v_pk_mul_f32 v[222:223], v[222:223], v[44:45] op_sel_hi:[1,0]
  v_cvt_pk_bf16_f32 v82, v220, v221
  v_cvt_pk_bf16_f32 v83, v222, v223
  ds_write_b128 v12, v[80:83] offset:0
  v_pk_mul_f32 v[212:213], v[212:213], v[46:47] op_sel_hi:[1,0]
  v_pk_mul_f32 v[214:215], v[214:215], v[46:47] op_sel_hi:[1,0]
  v_cvt_pk_bf16_f32 v68, v212, v213
  v_cvt_pk_bf16_f32 v69, v214, v215
  v_pk_mul_f32 v[224:225], v[224:225], v[46:47] op_sel_hi:[1,0]
  v_pk_mul_f32 v[226:227], v[226:227], v[46:47] op_sel_hi:[1,0]
  v_cvt_pk_bf16_f32 v70, v224, v225
  v_cvt_pk_bf16_f32 v71, v226, v227
  ds_write_b128 v12, v[68:71] offset:1024
  v_pk_mul_f32 v[216:217], v[216:217], v[48:49] op_sel_hi:[1,0]
  v_pk_mul_f32 v[218:219], v[218:219], v[48:49] op_sel_hi:[1,0]
  v_cvt_pk_bf16_f32 v72, v216, v217
  v_cvt_pk_bf16_f32 v73, v218, v219
  v_pk_mul_f32 v[228:229], v[228:229], v[48:49] op_sel_hi:[1,0]
  v_pk_mul_f32 v[230:231], v[230:231], v[48:49] op_sel_hi:[1,0]
  v_cvt_pk_bf16_f32 v74, v228, v229
  v_cvt_pk_bf16_f32 v75, v230, v231
  ds_write_b128 v12, v[72:75] offset:2048
  v_pk_mul_f32 v[232:233], v[232:233], v[44:45] op_sel_hi:[1,0]
  v_pk_mul_f32 v[234:235], v[234:235], v[44:45] op_sel_hi:[1,0]
  v_cvt_pk_bf16_f32 v76, v232, v233
  v_cvt_pk_bf16_f32 v77, v234, v235
  v_pk_mul_f32 v[244:245], v[244:245], v[44:45] op_sel_hi:[1,0]
  v_pk_mul_f32 v[246:247], v[246:247], v[44:45] op_sel_hi:[1,0]
  v_cvt_pk_bf16_f32 v78, v244, v245
  v_cvt_pk_bf16_f32 v79, v246, v247
  ds_write_b128 v8, v[76:79] offset:0
  v_pk_mul_f32 v[236:237], v[236:237], v[46:47] op_sel_hi:[1,0]
  v_pk_mul_f32 v[238:239], v[238:239], v[46:47] op_sel_hi:[1,0]
  v_cvt_pk_bf16_f32 v80, v236, v237
  v_cvt_pk_bf16_f32 v81, v238, v239
  v_pk_mul_f32 v[248:249], v[248:249], v[46:47] op_sel_hi:[1,0]
  v_pk_mul_f32 v[250:251], v[250:251], v[46:47] op_sel_hi:[1,0]
  v_cvt_pk_bf16_f32 v82, v248, v249
  v_cvt_pk_bf16_f32 v83, v250, v251
  ds_write_b128 v8, v[80:83] offset:1024
  v_pk_mul_f32 v[240:241], v[240:241], v[48:49] op_sel_hi:[1,0]
  v_pk_mul_f32 v[242:243], v[242:243], v[48:49] op_sel_hi:[1,0]
  v_cvt_pk_bf16_f32 v68, v240, v241
  v_cvt_pk_bf16_f32 v69, v242, v243
  v_pk_mul_f32 v[252:253], v[252:253], v[48:49] op_sel_hi:[1,0]
  v_pk_mul_f32 v[254:255], v[254:255], v[48:49] op_sel_hi:[1,0]
  v_cvt_pk_bf16_f32 v70, v252, v253
  v_cvt_pk_bf16_f32 v71, v254, v255
  ds_write_b128 v8, v[68:71] offset:2048
  v_pk_mul_f32 v[184:185], v[184:185], v[44:45] op_sel_hi:[1,0]
  v_pk_mul_f32 v[186:187], v[186:187], v[44:45] op_sel_hi:[1,0]
  v_pk_mul_f32 v[196:197], v[196:197], v[44:45] op_sel_hi:[1,0]
  v_pk_mul_f32 v[198:199], v[198:199], v[44:45] op_sel_hi:[1,0]
  v_pk_mul_f32 v[188:189], v[188:189], v[46:47] op_sel_hi:[1,0]
  v_pk_mul_f32 v[190:191], v[190:191], v[46:47] op_sel_hi:[1,0]
  v_pk_mul_f32 v[200:201], v[200:201], v[46:47] op_sel_hi:[1,0]
  v_pk_mul_f32 v[202:203], v[202:203], v[46:47] op_sel_hi:[1,0]
  v_pk_mul_f32 v[192:193], v[192:193], v[48:49] op_sel_hi:[1,0]
  v_pk_mul_f32 v[194:195], v[194:195], v[48:49] op_sel_hi:[1,0]
  v_pk_mul_f32 v[204:205], v[204:205], v[48:49] op_sel_hi:[1,0]
  v_pk_mul_f32 v[206:207], v[206:207], v[48:49] op_sel_hi:[1,0]
  s_waitcnt lgkmcnt(0)
  s_barrier
  s_setprio 0
  ds_read_b128 v[88:91], v4 offset:0
  ds_read_b128 v[92:95], v4 offset:1024
  ds_read_b128 v[96:99], v4 offset:2048
  ds_read_b128 v[100:103], v4 offset:3072
  ds_read_b128 v[104:107], v4 offset:4096
  ds_read_b128 v[108:111], v4 offset:5120
  ds_read_b128 v[32:35], v4 offset:6144
  ds_read_b128 v[36:39], v4 offset:7168
  ds_read_b128 v[40:43], v4 offset:8192
  s_waitcnt lgkmcnt(6)
  v_lshlrev_b32 v24, 16, v88
  v_and_b32 v25, s69, v88
  v_pk_add_f32 v[184:185], v[184:185], v[24:25]
  v_lshlrev_b32 v26, 16, v89
  v_and_b32 v27, s69, v89
  v_pk_add_f32 v[186:187], v[186:187], v[26:27]
  v_lshlrev_b32 v24, 16, v90
  v_and_b32 v25, s69, v90
  v_pk_add_f32 v[196:197], v[196:197], v[24:25]
  v_lshlrev_b32 v26, 16, v91
  v_and_b32 v27, s69, v91
  v_pk_add_f32 v[198:199], v[198:199], v[26:27]
  v_lshlrev_b32 v24, 16, v92
  v_and_b32 v25, s69, v92
  v_pk_add_f32 v[188:189], v[188:189], v[24:25]
  v_lshlrev_b32 v26, 16, v93
  v_and_b32 v27, s69, v93
  v_pk_add_f32 v[190:191], v[190:191], v[26:27]
  v_lshlrev_b32 v24, 16, v94
  v_and_b32 v25, s69, v94
  v_pk_add_f32 v[200:201], v[200:201], v[24:25]
  v_lshlrev_b32 v26, 16, v95
  v_and_b32 v27, s69, v95
  v_pk_add_f32 v[202:203], v[202:203], v[26:27]
  v_lshlrev_b32 v24, 16, v96
  v_and_b32 v25, s69, v96
  v_pk_add_f32 v[192:193], v[192:193], v[24:25]
  v_lshlrev_b32 v26, 16, v97
  v_and_b32 v27, s69, v97
  v_pk_add_f32 v[194:195], v[194:195], v[26:27]
  v_lshlrev_b32 v24, 16, v98
  v_and_b32 v25, s69, v98
  v_pk_add_f32 v[204:205], v[204:205], v[24:25]
  v_lshlrev_b32 v26, 16, v99
  v_and_b32 v27, s69, v99
  v_pk_add_f32 v[206:207], v[206:207], v[26:27]
  s_waitcnt lgkmcnt(3)
  v_lshlrev_b32 v24, 16, v100
  v_and_b32 v25, s69, v100
  v_pk_add_f32 v[184:185], v[184:185], v[24:25]
  v_lshlrev_b32 v26, 16, v101
  v_and_b32 v27, s69, v101
  v_pk_add_f32 v[186:187], v[186:187], v[26:27]
  v_lshlrev_b32 v24, 16, v102
  v_and_b32 v25, s69, v102
  v_pk_add_f32 v[196:197], v[196:197], v[24:25]
  v_lshlrev_b32 v26, 16, v103
  v_and_b32 v27, s69, v103
  v_pk_add_f32 v[198:199], v[198:199], v[26:27]
  v_lshlrev_b32 v24, 16, v104
  v_and_b32 v25, s69, v104
  v_pk_add_f32 v[188:189], v[188:189], v[24:25]
  v_lshlrev_b32 v26, 16, v105
  v_and_b32 v27, s69, v105
  v_pk_add_f32 v[190:191], v[190:191], v[26:27]
  v_lshlrev_b32 v24, 16, v106
  v_and_b32 v25, s69, v106
  v_pk_add_f32 v[200:201], v[200:201], v[24:25]
  v_lshlrev_b32 v26, 16, v107
  v_and_b32 v27, s69, v107
  v_pk_add_f32 v[202:203], v[202:203], v[26:27]
  v_lshlrev_b32 v24, 16, v108
  v_and_b32 v25, s69, v108
  v_pk_add_f32 v[192:193], v[192:193], v[24:25]
  v_lshlrev_b32 v26, 16, v109
  v_and_b32 v27, s69, v109
  v_pk_add_f32 v[194:195], v[194:195], v[26:27]
  v_lshlrev_b32 v24, 16, v110
  v_and_b32 v25, s69, v110
  v_pk_add_f32 v[204:205], v[204:205], v[24:25]
  v_lshlrev_b32 v26, 16, v111
  v_and_b32 v27, s69, v111
  v_pk_add_f32 v[206:207], v[206:207], v[26:27]
  s_waitcnt lgkmcnt(0)
  v_lshlrev_b32 v24, 16, v32
  v_and_b32 v25, s69, v32
  v_pk_add_f32 v[184:185], v[184:185], v[24:25]
  v_lshlrev_b32 v26, 16, v33
  v_and_b32 v27, s69, v33
  v_pk_add_f32 v[186:187], v[186:187], v[26:27]
  v_lshlrev_b32 v24, 16, v34
  v_and_b32 v25, s69, v34
  v_pk_add_f32 v[196:197], v[196:197], v[24:25]
  v_lshlrev_b32 v26, 16, v35
  v_and_b32 v27, s69, v35
  v_pk_add_f32 v[198:199], v[198:199], v[26:27]
  v_lshlrev_b32 v24, 16, v36
  v_and_b32 v25, s69, v36
  v_pk_add_f32 v[188:189], v[188:189], v[24:25]
  v_lshlrev_b32 v26, 16, v37
  v_and_b32 v27, s69, v37
  v_pk_add_f32 v[190:191], v[190:191], v[26:27]
  v_lshlrev_b32 v24, 16, v38
  v_and_b32 v25, s69, v38
  v_pk_add_f32 v[200:201], v[200:201], v[24:25]
  v_lshlrev_b32 v26, 16, v39
  v_and_b32 v27, s69, v39
  v_pk_add_f32 v[202:203], v[202:203], v[26:27]
  v_lshlrev_b32 v24, 16, v40
  v_and_b32 v25, s69, v40
  v_pk_add_f32 v[192:193], v[192:193], v[24:25]
  v_lshlrev_b32 v26, 16, v41
  v_and_b32 v27, s69, v41
  v_pk_add_f32 v[194:195], v[194:195], v[26:27]
  v_lshlrev_b32 v24, 16, v42
  v_and_b32 v25, s69, v42
  v_pk_add_f32 v[204:205], v[204:205], v[24:25]
  v_lshlrev_b32 v26, 16, v43
  v_and_b32 v27, s69, v43
  v_pk_add_f32 v[206:207], v[206:207], v[26:27]
  v_cvt_pk_bf16_f32 v56, v184, v185
  v_cvt_pk_bf16_f32 v57, v186, v187
  v_cvt_pk_bf16_f32 v58, v196, v197
  v_cvt_pk_bf16_f32 v59, v198, v199
  v_cvt_pk_bf16_f32 v60, v188, v189
  v_cvt_pk_bf16_f32 v61, v190, v191
  v_cvt_pk_bf16_f32 v62, v200, v201
  v_cvt_pk_bf16_f32 v63, v202, v203
  v_cvt_pk_bf16_f32 v64, v192, v193
  v_cvt_pk_bf16_f32 v65, v194, v195
  v_cvt_pk_bf16_f32 v66, v204, v205
  v_cvt_pk_bf16_f32 v67, v206, v207
  s_branch L_tail
L_role1:
  v_add_u32 v4, 0, v4
  v_add_u32 v5, 0, v5
  v_add_u32 v6, 0, v6
  s_waitcnt vmcnt(5)
  s_waitcnt lgkmcnt(0)
  s_barrier
  ds_read_b128 v[112:115], v16 offset:0
  ds_read_b128 v[116:119], v16 offset:1024
  ds_read_b128 v[120:123], v16 offset:2048
  ds_read_b128 v[124:127], v16 offset:3072
  ds_read_b128 v[128:131], v16 offset:4096
  ds_read_b128 v[132:135], v16 offset:5120
  ds_read_b128 v[136:139], v16 offset:6144
  ds_read_b128 v[140:143], v16 offset:7168
  ds_read_b128 v[144:147], v16 offset:8192
  ds_read_b128 v[148:151], v16 offset:9216
  ds_read_b128 v[152:155], v16 offset:10240
  ds_read_b128 v[156:159], v16 offset:11264
  s_setprio 0
  s_add_u32 m0, s63, 0x8000
  s_add_u32 s69, s62, 0x8000
  buffer_load_dwordx4 v7, s[8:11], s69 offen nt lds
  s_add_u32 m0, s63, 0xa000
  s_add_u32 s69, s62, 0x8000
  buffer_load_dwordx4 v8, s[12:15], s69 offen nt lds
  s_add_u32 m0, s63, 0xc000
  s_add_u32 s69, s62, 0xa000
  buffer_load_dwordx4 v7, s[8:11], s69 offen nt lds
  s_add_u32 m0, s63, 0xe000
  s_add_u32 s69, s62, 0xa000
  buffer_load_dwordx4 v8, s[12:15], s69 offen nt lds
  s_add_u32 m0, s63, 0x20000
  s_add_u32 s69, s62, 0xc000
  buffer_load_dwordx4 v7, s[8:11], s69 offen nt lds
  s_add_u32 m0, s63, 0x22000
  s_add_u32 s69, s62, 0xc000
  buffer_load_dwordx4 v8, s[12:15], s69 offen nt lds
  s_add_u32 m0, s63, 0x24000
  s_add_u32 s69, s62, 0xe000
  buffer_load_dwordx4 v7, s[8:11], s69 offen nt lds
  s_add_u32 m0, s63, 0x26000
  s_add_u32 s69, s62, 0xe000
  buffer_load_dwordx4 v8, s[12:15], s69 offen nt lds
  s_waitcnt vmcnt(9)
  s_waitcnt lgkmcnt(0)
  s_barrier
  s_setprio 3
  ds_read_b128 v[56:59], v4 offset:0
  ds_read_b128 v[60:63], v4 offset:256
  ds_read_b128 v[64:67], v4 offset:512
  ds_read_b128 v[68:71], v4 offset:768
  ds_read_b128 v[72:75], v4 offset:4096
  ds_read_b128 v[76:79], v4 offset:4352
  ds_read_b128 v[80:83], v4 offset:4608
  ds_read_b128 v[84:87], v4 offset:4864
  s_add_u32 m0, s63, 0x18000
  s_add_u32 s69, s62, 0x10000
  buffer_load_dwordx4 v7, s[8:11], s69 offen nt lds
  s_add_u32 m0, s63, 0x1a000
  s_add_u32 s69, s62, 0x10000
  buffer_load_dwordx4 v8, s[12:15], s69 offen nt lds
  s_add_u32 m0, s63, 0x1c000
  s_add_u32 s69, s62, 0x12000
  buffer_load_dwordx4 v7, s[8:11], s69 offen nt lds
  s_add_u32 m0, s63, 0x1e000
  s_add_u32 s69, s62, 0x12000
  buffer_load_dwordx4 v8, s[12:15], s69 offen nt lds
  s_add_u32 m0, s63, 0x10000
  s_add_u32 s69, s62, 0x14000
  buffer_load_dwordx4 v7, s[8:11], s69 offen nt lds
  s_add_u32 m0, s63, 0x12000
  s_add_u32 s69, s62, 0x14000
  buffer_load_dwordx4 v8, s[12:15], s69 offen nt lds
  s_add_u32 m0, s63, 0x14000
  s_add_u32 s69, s62, 0x16000
  buffer_load_dwordx4 v7, s[8:11], s69 offen nt lds
  s_add_u32 m0, s63, 0x16000
  s_add_u32 s69, s62, 0x16000
  buffer_load_dwordx4 v8, s[12:15], s69 offen nt lds
  s_waitcnt lgkmcnt(7)
  v_mfma_f32_16x16x32_bf16 v[88:91], v[56:59], v[112:115], 0
  s_waitcnt lgkmcnt(6)
  v_mfma_f32_16x16x32_bf16 v[88:91], v[60:63], v[116:119], v[88:91]
  s_waitcnt lgkmcnt(5)
  v_mfma_f32_16x16x32_bf16 v[88:91], v[64:67], v[120:123], v[88:91]
  s_waitcnt lgkmcnt(4)
  v_mfma_f32_16x16x32_bf16 v[88:91], v[68:71], v[124:127], v[88:91]
  s_waitcnt lgkmcnt(3)
  v_mfma_f32_16x16x32_bf16 v[100:103], v[72:75], v[112:115], 0
  s_waitcnt lgkmcnt(2)
  v_mfma_f32_16x16x32_bf16 v[100:103], v[76:79], v[116:119], v[100:103]
  s_waitcnt lgkmcnt(1)
  v_mfma_f32_16x16x32_bf16 v[100:103], v[80:83], v[120:123], v[100:103]
  s_waitcnt lgkmcnt(0)
  v_mfma_f32_16x16x32_bf16 v[100:103], v[84:87], v[124:127], v[100:103]
  v_mfma_f32_16x16x32_bf16 v[92:95], v[56:59], v[128:131], 0
  v_mfma_f32_16x16x32_bf16 v[92:95], v[60:63], v[132:135], v[92:95]
  v_mfma_f32_16x16x32_bf16 v[92:95], v[64:67], v[136:139], v[92:95]
  v_mfma_f32_16x16x32_bf16 v[92:95], v[68:71], v[140:143], v[92:95]
  v_mfma_f32_16x16x32_bf16 v[104:107], v[72:75], v[128:131], 0
  v_mfma_f32_16x16x32_bf16 v[104:107], v[76:79], v[132:135], v[104:107]
  v_mfma_f32_16x16x32_bf16 v[104:107], v[80:83], v[136:139], v[104:107]
  v_mfma_f32_16x16x32_bf16 v[104:107], v[84:87], v[140:143], v[104:107]
  v_mfma_f32_16x16x32_bf16 v[96:99], v[56:59], v[144:147], 0
  ds_read_b64_tr_b16 v[56:57], v5 offset:8192
  ds_read_b64_tr_b16 v[58:59], v5 offset:12288
  v_mfma_f32_16x16x32_bf16 v[96:99], v[60:63], v[148:151], v[96:99]
  ds_read_b64_tr_b16 v[60:61], v6 offset:8192
  ds_read_b64_tr_b16 v[62:63], v6 offset:12288
  v_mfma_f32_16x16x32_bf16 v[96:99], v[64:67], v[152:155], v[96:99]
  ds_read_b64_tr_b16 v[64:65], v5 offset:8704
  ds_read_b64_tr_b16 v[66:67], v5 offset:12800
  v_mfma_f32_16x16x32_bf16 v[96:99], v[68:71], v[156:159], v[96:99]
  ds_read_b64_tr_b16 v[68:69], v6 offset:8704
  ds_read_b64_tr_b16 v[70:71], v6 offset:12800
  v_mfma_f32_16x16x32_bf16 v[108:111], v[72:75], v[144:147], 0
  ds_read_b64_tr_b16 v[72:73], v5 offset:9216
  ds_read_b64_tr_b16 v[74:75], v5 offset:13312
  v_mfma_f32_16x16x32_bf16 v[108:111], v[76:79], v[148:151], v[108:111]
  ds_read_b64_tr_b16 v[76:77], v6 offset:9216
  ds_read_b64_tr_b16 v[78:79], v6 offset:13312
  v_mfma_f32_16x16x32_bf16 v[108:111], v[80:83], v[152:155], v[108:111]
  ds_read_b64_tr_b16 v[80:81], v5 offset:9728
  ds_read_b64_tr_b16 v[82:83], v5 offset:13824
  v_mfma_f32_16x16x32_bf16 v[108:111], v[84:87], v[156:159], v[108:111]
  ds_read_b64_tr_b16 v[84:85], v6 offset:9728
  ds_read_b64_tr_b16 v[86:87], v6 offset:13824
  v_max3_f32 v24, v88, v89, v90
  v_max3_f32 v24, v24, v91, v100
  v_max3_f32 v24, v24, v101, v102
  v_max_f32 v24, v24, v103
  v_mov_b32 v30, v24
  v_mov_b32 v31, v24
  s_nop 1
  v_permlane16_swap_b32 v30, v31
  s_nop 1
  v_max_f32 v30, v30, v31
  v_mov_b32 v31, v30
  s_nop 1
  v_permlane32_swap_b32 v30, v31
  s_nop 1
  v_max_f32 v24, v30, v31
  v_sub_f32 v32, 0, v24
  v_sub_f32 v33, 0, v24
  v_sub_f32 v34, 0, v24
  v_sub_f32 v35, 0, v24
  v_sub_f32 v88, v88, v24
  v_sub_f32 v89, v89, v24
  v_sub_f32 v90, v90, v24
  v_sub_f32 v91, v91, v24
  v_sub_f32 v100, v100, v24
  v_sub_f32 v101, v101, v24
  v_sub_f32 v102, v102, v24
  v_sub_f32 v103, v103, v24
  v_mov_b32 v9, 0
  v_exp_f32 v24, v88
  v_exp_f32 v25, v89
  v_exp_f32 v26, v90
  v_exp_f32 v27, v91
  v_add_f32 v12, v24, v25
  v_cvt_pk_bf16_f32 v44, v24, v25
  v_add_f32 v12, v12, v26
  v_exp_f32 v28, v100
  v_exp_f32 v29, v101
  v_cvt_pk_bf16_f32 v45, v26, v27
  v_add_f32 v12, v12, v27
  v_exp_f32 v30, v102
  v_exp_f32 v31, v103
  v_add_f32 v12, v12, v28
  v_cvt_pk_bf16_f32 v46, v28, v29
  v_add_f32 v12, v12, v29
  v_add_f32 v12, v12, v30
  v_cvt_pk_bf16_f32 v47, v30, v31
  v_add_f32 v12, v12, v31
  v_add_f32 v9, v9, v12
  v_max3_f32 v24, v92, v93, v94
  v_max3_f32 v24, v24, v95, v104
  v_max3_f32 v24, v24, v105, v106
  v_max_f32 v24, v24, v107
  v_mov_b32 v30, v24
  v_mov_b32 v31, v24
  s_nop 1
  v_permlane16_swap_b32 v30, v31
  s_nop 1
  v_max_f32 v30, v30, v31
  v_mov_b32 v31, v30
  s_nop 1
  v_permlane32_swap_b32 v30, v31
  s_nop 1
  v_max_f32 v24, v30, v31
  v_sub_f32 v36, 0, v24
  v_sub_f32 v37, 0, v24
  v_sub_f32 v38, 0, v24
  v_sub_f32 v39, 0, v24
  v_sub_f32 v92, v92, v24
  v_sub_f32 v93, v93, v24
  v_sub_f32 v94, v94, v24
  v_sub_f32 v95, v95, v24
  v_sub_f32 v104, v104, v24
  v_sub_f32 v105, v105, v24
  v_sub_f32 v106, v106, v24
  v_sub_f32 v107, v107, v24
  v_mov_b32 v10, 0
  v_exp_f32 v24, v92
  v_exp_f32 v25, v93
  v_exp_f32 v26, v94
  v_exp_f32 v27, v95
  v_add_f32 v13, v24, v25
  v_cvt_pk_bf16_f32 v48, v24, v25
  v_add_f32 v13, v13, v26
  v_exp_f32 v28, v104
  v_exp_f32 v29, v105
  v_cvt_pk_bf16_f32 v49, v26, v27
  v_add_f32 v13, v13, v27
  v_exp_f32 v30, v106
  v_exp_f32 v31, v107
  v_add_f32 v13, v13, v28
  v_cvt_pk_bf16_f32 v50, v28, v29
  v_add_f32 v13, v13, v29
  v_add_f32 v13, v13, v30
  v_cvt_pk_bf16_f32 v51, v30, v31
  v_add_f32 v13, v13, v31
  v_add_f32 v10, v10, v13
  v_max3_f32 v24, v96, v97, v98
  v_max3_f32 v24, v24, v99, v108
  v_max3_f32 v24, v24, v109, v110
  v_max_f32 v24, v24, v111
  v_mov_b32 v30, v24
  v_mov_b32 v31, v24
  s_nop 1
  v_permlane16_swap_b32 v30, v31
  s_nop 1
  v_max_f32 v30, v30, v31
  v_mov_b32 v31, v30
  s_nop 1
  v_permlane32_swap_b32 v30, v31
  s_nop 1
  v_max_f32 v24, v30, v31
  v_sub_f32 v40, 0, v24
  v_sub_f32 v41, 0, v24
  v_sub_f32 v42, 0, v24
  v_sub_f32 v43, 0, v24
  v_sub_f32 v96, v96, v24
  v_sub_f32 v97, v97, v24
  v_sub_f32 v98, v98, v24
  v_sub_f32 v99, v99, v24
  v_sub_f32 v108, v108, v24
  v_sub_f32 v109, v109, v24
  v_sub_f32 v110, v110, v24
  v_sub_f32 v111, v111, v24
  v_mov_b32 v11, 0
  v_exp_f32 v24, v96
  v_exp_f32 v25, v97
  v_exp_f32 v26, v98
  v_exp_f32 v27, v99
  v_add_f32 v14, v24, v25
  v_cvt_pk_bf16_f32 v52, v24, v25
  v_add_f32 v14, v14, v26
  v_exp_f32 v28, v108
  v_exp_f32 v29, v109
  v_cvt_pk_bf16_f32 v53, v26, v27
  v_add_f32 v14, v14, v27
  v_exp_f32 v30, v110
  v_exp_f32 v31, v111
  v_add_f32 v14, v14, v28
  v_cvt_pk_bf16_f32 v54, v28, v29
  v_add_f32 v14, v14, v29
  v_add_f32 v14, v14, v30
  v_cvt_pk_bf16_f32 v55, v30, v31
  v_add_f32 v14, v14, v31
  v_add_f32 v11, v11, v14
  v_add_u32 v4, 0x20000, v4
  v_add_u32 v5, 0x20000, v5
  v_add_u32 v6, 0x20000, v6
  s_waitcnt vmcnt(12)
  s_waitcnt lgkmcnt(0)
  s_barrier
  s_setprio 0
  v_mfma_f32_16x16x32_bf16 v[160:163], v[56:59], v[44:47], 0
  v_mfma_f32_16x16x32_bf16 v[172:175], v[60:63], v[44:47], 0
  v_mfma_f32_16x16x32_bf16 v[184:187], v[64:67], v[44:47], 0
  v_mfma_f32_16x16x32_bf16 v[196:199], v[68:71], v[44:47], 0
  v_mfma_f32_16x16x32_bf16 v[208:211], v[72:75], v[44:47], 0
  v_mfma_f32_16x16x32_bf16 v[220:223], v[76:79], v[44:47], 0
  v_mfma_f32_16x16x32_bf16 v[232:235], v[80:83], v[44:47], 0
  v_mfma_f32_16x16x32_bf16 v[244:247], v[84:87], v[44:47], 0
  v_mfma_f32_16x16x32_bf16 v[164:167], v[56:59], v[48:51], 0
  v_mfma_f32_16x16x32_bf16 v[176:179], v[60:63], v[48:51], 0
  v_mfma_f32_16x16x32_bf16 v[188:191], v[64:67], v[48:51], 0
  v_mfma_f32_16x16x32_bf16 v[200:203], v[68:71], v[48:51], 0
  v_mfma_f32_16x16x32_bf16 v[212:215], v[72:75], v[48:51], 0
  v_mfma_f32_16x16x32_bf16 v[224:227], v[76:79], v[48:51], 0
  v_mfma_f32_16x16x32_bf16 v[236:239], v[80:83], v[48:51], 0
  v_mfma_f32_16x16x32_bf16 v[248:251], v[84:87], v[48:51], 0
  s_nop 1
  v_mfma_f32_16x16x32_bf16 v[168:171], v[56:59], v[52:55], 0
  s_add_u32 m0, s63, 0x0
  s_add_u32 s69, s62, 0x18000
  buffer_load_dwordx4 v7, s[8:11], s69 offen nt lds
  v_mfma_f32_16x16x32_bf16 v[180:183], v[60:63], v[52:55], 0
  v_mfma_f32_16x16x32_bf16 v[192:195], v[64:67], v[52:55], 0
  s_add_u32 m0, s63, 0x2000
  s_add_u32 s69, s62, 0x18000
  buffer_load_dwordx4 v8, s[12:15], s69 offen nt lds
  v_mfma_f32_16x16x32_bf16 v[204:207], v[68:71], v[52:55], 0
  v_mfma_f32_16x16x32_bf16 v[216:219], v[72:75], v[52:55], 0
  s_add_u32 m0, s63, 0x4000
  s_add_u32 s69, s62, 0x1a000
  buffer_load_dwordx4 v7, s[8:11], s69 offen nt lds
  v_mfma_f32_16x16x32_bf16 v[228:231], v[76:79], v[52:55], 0
  v_mfma_f32_16x16x32_bf16 v[240:243], v[80:83], v[52:55], 0
  s_add_u32 m0, s63, 0x6000
  s_add_u32 s69, s62, 0x1a000
  buffer_load_dwordx4 v8, s[12:15], s69 offen nt lds
  v_mfma_f32_16x16x32_bf16 v[252:255], v[84:87], v[52:55], 0
  s_waitcnt vmcnt(12)
  s_waitcnt lgkmcnt(0)
  s_barrier
  s_setprio 3
  ds_read_b128 v[56:59], v4 offset:0
  ds_read_b128 v[60:63], v4 offset:256
  ds_read_b128 v[64:67], v4 offset:512
  ds_read_b128 v[68:71], v4 offset:768
  ds_read_b128 v[72:75], v4 offset:4096
  ds_read_b128 v[76:79], v4 offset:4352
  ds_read_b128 v[80:83], v4 offset:4608
  ds_read_b128 v[84:87], v4 offset:4864
  s_add_u32 m0, s63, 0x8000
  s_add_u32 s69, s62, 0x1c000
  buffer_load_dwordx4 v7, s[8:11], s69 offen nt lds
  s_add_u32 m0, s63, 0xa000
  s_add_u32 s69, s62, 0x1c000
  buffer_load_dwordx4 v8, s[12:15], s69 offen nt lds
  s_add_u32 m0, s63, 0xc000
  s_add_u32 s69, s62, 0x1e000
  buffer_load_dwordx4 v7, s[8:11], s69 offen nt lds
  s_add_u32 m0, s63, 0xe000
  s_add_u32 s69, s62, 0x1e000
  buffer_load_dwordx4 v8, s[12:15], s69 offen nt lds
  s_waitcnt lgkmcnt(7)
  v_mfma_f32_16x16x32_bf16 v[88:91], v[56:59], v[112:115], v[32:35]
  s_waitcnt lgkmcnt(6)
  v_mfma_f32_16x16x32_bf16 v[88:91], v[60:63], v[116:119], v[88:91]
  s_waitcnt lgkmcnt(5)
  v_mfma_f32_16x16x32_bf16 v[88:91], v[64:67], v[120:123], v[88:91]
  s_waitcnt lgkmcnt(4)
  v_mfma_f32_16x16x32_bf16 v[88:91], v[68:71], v[124:127], v[88:91]
  s_waitcnt lgkmcnt(3)
  v_mfma_f32_16x16x32_bf16 v[100:103], v[72:75], v[112:115], v[32:35]
  s_waitcnt lgkmcnt(2)
  v_mfma_f32_16x16x32_bf16 v[100:103], v[76:79], v[116:119], v[100:103]
  s_waitcnt lgkmcnt(1)
  v_mfma_f32_16x16x32_bf16 v[100:103], v[80:83], v[120:123], v[100:103]
  s_waitcnt lgkmcnt(0)
  v_mfma_f32_16x16x32_bf16 v[100:103], v[84:87], v[124:127], v[100:103]
  v_mfma_f32_16x16x32_bf16 v[92:95], v[56:59], v[128:131], v[36:39]
  v_exp_f32 v24, v88
  v_exp_f32 v25, v89
  v_mfma_f32_16x16x32_bf16 v[92:95], v[60:63], v[132:135], v[92:95]
  v_exp_f32 v26, v90
  v_exp_f32 v27, v91
  v_mfma_f32_16x16x32_bf16 v[92:95], v[64:67], v[136:139], v[92:95]
  v_add_f32 v12, v24, v25
  v_cvt_pk_bf16_f32 v44, v24, v25
  v_mfma_f32_16x16x32_bf16 v[92:95], v[68:71], v[140:143], v[92:95]
  v_add_f32 v12, v12, v26
  v_exp_f32 v28, v100
  v_mfma_f32_16x16x32_bf16 v[104:107], v[72:75], v[128:131], v[36:39]
  v_exp_f32 v29, v101
  v_cvt_pk_bf16_f32 v45, v26, v27
  v_mfma_f32_16x16x32_bf16 v[104:107], v[76:79], v[132:135], v[104:107]
  v_add_f32 v12, v12, v27
  v_exp_f32 v30, v102
  v_mfma_f32_16x16x32_bf16 v[104:107], v[80:83], v[136:139], v[104:107]
  v_exp_f32 v31, v103
  v_add_f32 v12, v12, v28
  v_mfma_f32_16x16x32_bf16 v[104:107], v[84:87], v[140:143], v[104:107]
  v_cvt_pk_bf16_f32 v46, v28, v29
  v_add_f32 v12, v12, v29
  v_mfma_f32_16x16x32_bf16 v[96:99], v[56:59], v[144:147], v[40:43]
  ds_read_b64_tr_b16 v[56:57], v5 offset:8192
  ds_read_b64_tr_b16 v[58:59], v5 offset:12288
  v_add_f32 v12, v12, v30
  v_cvt_pk_bf16_f32 v47, v30, v31
  v_add_f32 v12, v12, v31
  v_mfma_f32_16x16x32_bf16 v[96:99], v[60:63], v[148:151], v[96:99]
  ds_read_b64_tr_b16 v[60:61], v6 offset:8192
  ds_read_b64_tr_b16 v[62:63], v6 offset:12288
  v_cmp_lt_f32 vcc, s72, v12
  s_cbranch_vccz Lok_23
  s_swappc_b64 s[76:77], s[78:79]
Lok_23:
  v_add_f32 v9, v9, v12
  v_mfma_f32_16x16x32_bf16 v[96:99], v[64:67], v[152:155], v[96:99]
  ds_read_b64_tr_b16 v[64:65], v5 offset:8704
  ds_read_b64_tr_b16 v[66:67], v5 offset:12800
  v_exp_f32 v24, v92
  v_exp_f32 v25, v93
  v_mfma_f32_16x16x32_bf16 v[96:99], v[68:71], v[156:159], v[96:99]
  ds_read_b64_tr_b16 v[68:69], v6 offset:8704
  ds_read_b64_tr_b16 v[70:71], v6 offset:12800
  v_exp_f32 v26, v94
  v_exp_f32 v27, v95
  v_mfma_f32_16x16x32_bf16 v[108:111], v[72:75], v[144:147], v[40:43]
  ds_read_b64_tr_b16 v[72:73], v5 offset:9216
  ds_read_b64_tr_b16 v[74:75], v5 offset:13312
  v_add_f32 v13, v24, v25
  v_cvt_pk_bf16_f32 v48, v24, v25
  v_mfma_f32_16x16x32_bf16 v[108:111], v[76:79], v[148:151], v[108:111]
  ds_read_b64_tr_b16 v[76:77], v6 offset:9216
  ds_read_b64_tr_b16 v[78:79], v6 offset:13312
  v_add_f32 v13, v13, v26
  v_exp_f32 v28, v104
  v_mfma_f32_16x16x32_bf16 v[108:111], v[80:83], v[152:155], v[108:111]
  ds_read_b64_tr_b16 v[80:81], v5 offset:9728
  ds_read_b64_tr_b16 v[82:83], v5 offset:13824
  v_exp_f32 v29, v105
  v_cvt_pk_bf16_f32 v49, v26, v27
  v_mfma_f32_16x16x32_bf16 v[108:111], v[84:87], v[156:159], v[108:111]
  ds_read_b64_tr_b16 v[84:85], v6 offset:9728
  ds_read_b64_tr_b16 v[86:87], v6 offset:13824
  v_add_f32 v13, v13, v27
  v_exp_f32 v30, v106
  v_add_u32 v4, 0xffff0000, v4
  v_add_u32 v5, 0xffff0000, v5
  v_add_u32 v6, 0xffff0000, v6
  v_exp_f32 v31, v107
  v_add_f32 v13, v13, v28
  v_cvt_pk_bf16_f32 v50, v28, v29
  v_add_f32 v13, v13, v29
  v_add_f32 v13, v13, v30
  v_cvt_pk_bf16_f32 v51, v30, v31
  v_add_f32 v13, v13, v31
  v_cmp_lt_f32 vcc, s72, v13
  s_cbranch_vccz Lok_24
  s_swappc_b64 s[76:77], s[80:81]
Lok_24:
  v_add_f32 v10, v10, v13
  s_waitcnt vmcnt(12)
  s_waitcnt lgkmcnt(0)
  s_barrier
  s_setprio 0
  v_mfma_f32_16x16x32_bf16 v[160:163], v[56:59], v[44:47], v[160:163]
  v_exp_f32 v24, v96
  v_exp_f32 v25, v97
  v_mfma_f32_16x16x32_bf16 v[172:175], v[60:63], v[44:47], v[172:175]
  v_exp_f32 v26, v98
  v_mfma_f32_16x16x32_bf16 v[184:187], v[64:67], v[44:47], v[184:187]
  v_exp_f32 v27, v99
  v_mfma_f32_16x16x32_bf16 v[196:199], v[68:71], v[44:47], v[196:199]
  v_add_f32 v14, v24, v25
  v_cvt_pk_bf16_f32 v52, v24, v25
  v_mfma_f32_16x16x32_bf16 v[208:211], v[72:75], v[44:47], v[208:211]
  v_add_f32 v14, v14, v26
  v_mfma_f32_16x16x32_bf16 v[220:223], v[76:79], v[44:47], v[220:223]
  v_exp_f32 v28, v108
  v_mfma_f32_16x16x32_bf16 v[232:235], v[80:83], v[44:47], v[232:235]
  v_exp_f32 v29, v109
  v_cvt_pk_bf16_f32 v53, v26, v27
  v_mfma_f32_16x16x32_bf16 v[244:247], v[84:87], v[44:47], v[244:247]
  v_add_f32 v14, v14, v27
  v_mfma_f32_16x16x32_bf16 v[164:167], v[56:59], v[48:51], v[164:167]
  v_exp_f32 v30, v110
  v_mfma_f32_16x16x32_bf16 v[176:179], v[60:63], v[48:51], v[176:179]
  v_exp_f32 v31, v111
  v_add_f32 v14, v14, v28
  v_mfma_f32_16x16x32_bf16 v[188:191], v[64:67], v[48:51], v[188:191]
  v_cvt_pk_bf16_f32 v54, v28, v29
  v_mfma_f32_16x16x32_bf16 v[200:203], v[68:71], v[48:51], v[200:203]
  v_add_f32 v14, v14, v29
  v_mfma_f32_16x16x32_bf16 v[212:215], v[72:75], v[48:51], v[212:215]
  v_add_f32 v14, v14, v30
  v_cvt_pk_bf16_f32 v55, v30, v31
  v_mfma_f32_16x16x32_bf16 v[224:227], v[76:79], v[48:51], v[224:227]
  v_add_f32 v14, v14, v31
  v_mfma_f32_16x16x32_bf16 v[236:239], v[80:83], v[48:51], v[236:239]
  v_cmp_lt_f32 vcc, s72, v14
  s_cbranch_vccz Lok_25
  s_swappc_b64 s[76:77], s[82:83]
Lok_25:
  v_mfma_f32_16x16x32_bf16 v[248:251], v[84:87], v[48:51], v[248:251]
  v_add_f32 v11, v11, v14
  s_nop 1
  v_mfma_f32_16x16x32_bf16 v[168:171], v[56:59], v[52:55], v[168:171]
  s_add_u32 m0, s63, 0x20000
  s_add_u32 s69, s62, 0x20000
  buffer_load_dwordx4 v7, s[8:11], s69 offen nt lds
  v_mfma_f32_16x16x32_bf16 v[180:183], v[60:63], v[52:55], v[180:183]
  v_mfma_f32_16x16x32_bf16 v[192:195], v[64:67], v[52:55], v[192:195]
  s_add_u32 m0, s63, 0x22000
  s_add_u32 s69, s62, 0x20000
  buffer_load_dwordx4 v8, s[12:15], s69 offen nt lds
  v_mfma_f32_16x16x32_bf16 v[204:207], v[68:71], v[52:55], v[204:207]
  v_mfma_f32_16x16x32_bf16 v[216:219], v[72:75], v[52:55], v[216:219]
  s_add_u32 m0, s63, 0x24000
  s_add_u32 s69, s62, 0x22000
  buffer_load_dwordx4 v7, s[8:11], s69 offen nt lds
  v_mfma_f32_16x16x32_bf16 v[228:231], v[76:79], v[52:55], v[228:231]
  v_mfma_f32_16x16x32_bf16 v[240:243], v[80:83], v[52:55], v[240:243]
  s_add_u32 m0, s63, 0x26000
  s_add_u32 s69, s62, 0x22000
  buffer_load_dwordx4 v8, s[12:15], s69 offen nt lds
  v_mfma_f32_16x16x32_bf16 v[252:255], v[84:87], v[52:55], v[252:255]
  s_waitcnt vmcnt(12)
  s_waitcnt lgkmcnt(0)
  s_barrier
  s_setprio 3
  ds_read_b128 v[56:59], v4 offset:0
  ds_read_b128 v[60:63], v4 offset:256
  ds_read_b128 v[64:67], v4 offset:512
  ds_read_b128 v[68:71], v4 offset:768
  ds_read_b128 v[72:75], v4 offset:4096
  ds_read_b128 v[76:79], v4 offset:4352
  ds_read_b128 v[80:83], v4 offset:4608
  ds_read_b128 v[84:87], v4 offset:4864
  s_add_u32 m0, s63, 0x18000
  s_add_u32 s69, s62, 0x24000
  buffer_load_dwordx4 v7, s[8:11], s69 offen nt lds
  s_add_u32 m0, s63, 0x1a000
  s_add_u32 s69, s62, 0x24000
  buffer_load_dwordx4 v8, s[12:15], s69 offen nt lds
  s_add_u32 m0, s63, 0x1c000
  s_add_u32 s69, s62, 0x26000
  buffer_load_dwordx4 v7, s[8:11], s69 offen nt lds
  s_add_u32 m0, s63, 0x1e000
  s_add_u32 s69, s62, 0x26000
  buffer_load_dwordx4 v8, s[12:15], s69 offen nt lds
  s_waitcnt lgkmcnt(7)
  v_mfma_f32_16x16x32_bf16 v[88:91], v[56:59], v[112:115], v[32:35]
  s_waitcnt lgkmcnt(6)
  v_mfma_f32_16x16x32_bf16 v[88:91], v[60:63], v[116:119], v[88:91]
  s_waitcnt lgkmcnt(5)
  v_mfma_f32_16x16x32_bf16 v[88:91], v[64:67], v[120:123], v[88:91]
  s_waitcnt lgkmcnt(4)
  v_mfma_f32_16x16x32_bf16 v[88:91], v[68:71], v[124:127], v[88:91]
  s_waitcnt lgkmcnt(3)
  v_mfma_f32_16x16x32_bf16 v[100:103], v[72:75], v[112:115], v[32:35]
  s_waitcnt lgkmcnt(2)
  v_mfma_f32_16x16x32_bf16 v[100:103], v[76:79], v[116:119], v[100:103]
  s_waitcnt lgkmcnt(1)
  v_mfma_f32_16x16x32_bf16 v[100:103], v[80:83], v[120:123], v[100:103]
  s_waitcnt lgkmcnt(0)
  v_mfma_f32_16x16x32_bf16 v[100:103], v[84:87], v[124:127], v[100:103]
  v_mfma_f32_16x16x32_bf16 v[92:95], v[56:59], v[128:131], v[36:39]
  v_exp_f32 v24, v88
  v_exp_f32 v25, v89
  v_mfma_f32_16x16x32_bf16 v[92:95], v[60:63], v[132:135], v[92:95]
  v_exp_f32 v26, v90
  v_exp_f32 v27, v91
  v_mfma_f32_16x16x32_bf16 v[92:95], v[64:67], v[136:139], v[92:95]
  v_add_f32 v12, v24, v25
  v_cvt_pk_bf16_f32 v44, v24, v25
  v_mfma_f32_16x16x32_bf16 v[92:95], v[68:71], v[140:143], v[92:95]
  v_add_f32 v12, v12, v26
  v_exp_f32 v28, v100
  v_mfma_f32_16x16x32_bf16 v[104:107], v[72:75], v[128:131], v[36:39]
  v_exp_f32 v29, v101
  v_cvt_pk_bf16_f32 v45, v26, v27
  v_mfma_f32_16x16x32_bf16 v[104:107], v[76:79], v[132:135], v[104:107]
  v_add_f32 v12, v12, v27
  v_exp_f32 v30, v102
  v_mfma_f32_16x16x32_bf16 v[104:107], v[80:83], v[136:139], v[104:107]
  v_exp_f32 v31, v103
  v_add_f32 v12, v12, v28
  v_mfma_f32_16x16x32_bf16 v[104:107], v[84:87], v[140:143], v[104:107]
  v_cvt_pk_bf16_f32 v46, v28, v29
  v_add_f32 v12, v12, v29
  v_mfma_f32_16x16x32_bf16 v[96:99], v[56:59], v[144:147], v[40:43]
  ds_read_b64_tr_b16 v[56:57], v5 offset:8192
  ds_read_b64_tr_b16 v[58:59], v5 offset:12288
  v_add_f32 v12, v12, v30
  v_cvt_pk_bf16_f32 v47, v30, v31
  v_add_f32 v12, v12, v31
  v_mfma_f32_16x16x32_bf16 v[96:99], v[60:63], v[148:151], v[96:99]
  ds_read_b64_tr_b16 v[60:61], v6 offset:8192
  ds_read_b64_tr_b16 v[62:63], v6 offset:12288
  v_cmp_lt_f32 vcc, s72, v12
  s_cbranch_vccz Lok_26
  s_swappc_b64 s[76:77], s[78:79]
Lok_26:
  v_add_f32 v9, v9, v12
  v_mfma_f32_16x16x32_bf16 v[96:99], v[64:67], v[152:155], v[96:99]
  ds_read_b64_tr_b16 v[64:65], v5 offset:8704
  ds_read_b64_tr_b16 v[66:67], v5 offset:12800
  v_exp_f32 v24, v92
  v_exp_f32 v25, v93
  v_mfma_f32_16x16x32_bf16 v[96:99], v[68:71], v[156:159], v[96:99]
  ds_read_b64_tr_b16 v[68:69], v6 offset:8704
  ds_read_b64_tr_b16 v[70:71], v6 offset:12800
  v_exp_f32 v26, v94
  v_exp_f32 v27, v95
  v_mfma_f32_16x16x32_bf16 v[108:111], v[72:75], v[144:147], v[40:43]
  ds_read_b64_tr_b16 v[72:73], v5 offset:9216
  ds_read_b64_tr_b16 v[74:75], v5 offset:13312
  v_add_f32 v13, v24, v25
  v_cvt_pk_bf16_f32 v48, v24, v25
  v_mfma_f32_16x16x32_bf16 v[108:111], v[76:79], v[148:151], v[108:111]
  ds_read_b64_tr_b16 v[76:77], v6 offset:9216
  ds_read_b64_tr_b16 v[78:79], v6 offset:13312
  v_add_f32 v13, v13, v26
  v_exp_f32 v28, v104
  v_mfma_f32_16x16x32_bf16 v[108:111], v[80:83], v[152:155], v[108:111]
  ds_read_b64_tr_b16 v[80:81], v5 offset:9728
  ds_read_b64_tr_b16 v[82:83], v5 offset:13824
  v_exp_f32 v29, v105
  v_cvt_pk_bf16_f32 v49, v26, v27
  v_mfma_f32_16x16x32_bf16 v[108:111], v[84:87], v[156:159], v[108:111]
  ds_read_b64_tr_b16 v[84:85], v6 offset:9728
  ds_read_b64_tr_b16 v[86:87], v6 offset:13824
  v_add_f32 v13, v13, v27
  v_exp_f32 v30, v106
  v_add_u32 v4, 0xffff8000, v4
  v_add_u32 v5, 0xffff8000, v5
  v_add_u32 v6, 0xffff8000, v6
  v_exp_f32 v31, v107
  v_add_f32 v13, v13, v28
  v_cvt_pk_bf16_f32 v50, v28, v29
  v_add_f32 v13, v13, v29
  v_add_f32 v13, v13, v30
  v_cvt_pk_bf16_f32 v51, v30, v31
  v_add_f32 v13, v13, v31
  v_cmp_lt_f32 vcc, s72, v13
  s_cbranch_vccz Lok_27
  s_swappc_b64 s[76:77], s[80:81]
Lok_27:
  v_add_f32 v10, v10, v13
  s_waitcnt vmcnt(12)
  s_waitcnt lgkmcnt(0)
  s_barrier
  s_setprio 0
  v_mfma_f32_16x16x32_bf16 v[160:163], v[56:59], v[44:47], v[160:163]
  v_exp_f32 v24, v96
  v_exp_f32 v25, v97
  v_mfma_f32_16x16x32_bf16 v[172:175], v[60:63], v[44:47], v[172:175]
  v_exp_f32 v26, v98
  v_mfma_f32_16x16x32_bf16 v[184:187], v[64:67], v[44:47], v[184:187]
  v_exp_f32 v27, v99
  v_mfma_f32_16x16x32_bf16 v[196:199], v[68:71], v[44:47], v[196:199]
  v_add_f32 v14, v24, v25
  v_cvt_pk_bf16_f32 v52, v24, v25
  v_mfma_f32_16x16x32_bf16 v[208:211], v[72:75], v[44:47], v[208:211]
  v_add_f32 v14, v14, v26
  v_mfma_f32_16x16x32_bf16 v[220:223], v[76:79], v[44:47], v[220:223]
  v_exp_f32 v28, v108
  v_mfma_f32_16x16x32_bf16 v[232:235], v[80:83], v[44:47], v[232:235]
  v_exp_f32 v29, v109
  v_cvt_pk_bf16_f32 v53, v26, v27
  v_mfma_f32_16x16x32_bf16 v[244:247], v[84:87], v[44:47], v[244:247]
  v_add_f32 v14, v14, v27
  v_mfma_f32_16x16x32_bf16 v[164:167], v[56:59], v[48:51], v[164:167]
  v_exp_f32 v30, v110
  v_mfma_f32_16x16x32_bf16 v[176:179], v[60:63], v[48:51], v[176:179]
  v_exp_f32 v31, v111
  v_add_f32 v14, v14, v28
  v_mfma_f32_16x16x32_bf16 v[188:191], v[64:67], v[48:51], v[188:191]
  v_cvt_pk_bf16_f32 v54, v28, v29
  v_mfma_f32_16x16x32_bf16 v[200:203], v[68:71], v[48:51], v[200:203]
  v_add_f32 v14, v14, v29
  v_mfma_f32_16x16x32_bf16 v[212:215], v[72:75], v[48:51], v[212:215]
  v_add_f32 v14, v14, v30
  v_cvt_pk_bf16_f32 v55, v30, v31
  v_mfma_f32_16x16x32_bf16 v[224:227], v[76:79], v[48:51], v[224:227]
  v_add_f32 v14, v14, v31
  v_mfma_f32_16x16x32_bf16 v[236:239], v[80:83], v[48:51], v[236:239]
  v_cmp_lt_f32 vcc, s72, v14
  s_cbranch_vccz Lok_28
  s_swappc_b64 s[76:77], s[82:83]
Lok_28:
  v_mfma_f32_16x16x32_bf16 v[248:251], v[84:87], v[48:51], v[248:251]
  v_add_f32 v11, v11, v14
  s_nop 1
  v_mfma_f32_16x16x32_bf16 v[168:171], v[56:59], v[52:55], v[168:171]
  s_add_u32 m0, s63, 0x10000
  s_add_u32 s69, s62, 0x28000
  buffer_load_dwordx4 v7, s[8:11], s69 offen nt lds
  v_mfma_f32_16x16x32_bf16 v[180:183], v[60:63], v[52:55], v[180:183]
  v_mfma_f32_16x16x32_bf16 v[192:195], v[64:67], v[52:55], v[192:195]
  s_add_u32 m0, s63, 0x12000
  s_add_u32 s69, s62, 0x28000
  buffer_load_dwordx4 v8, s[12:15], s69 offen nt lds
  v_mfma_f32_16x16x32_bf16 v[204:207], v[68:71], v[52:55], v[204:207]
  v_mfma_f32_16x16x32_bf16 v[216:219], v[72:75], v[52:55], v[216:219]
  s_add_u32 m0, s63, 0x14000
  s_add_u32 s69, s62, 0x2a000
  buffer_load_dwordx4 v7, s[8:11], s69 offen nt lds
  v_mfma_f32_16x16x32_bf16 v[228:231], v[76:79], v[52:55], v[228:231]
  v_mfma_f32_16x16x32_bf16 v[240:243], v[80:83], v[52:55], v[240:243]
  s_add_u32 m0, s63, 0x16000
  s_add_u32 s69, s62, 0x2a000
  buffer_load_dwordx4 v8, s[12:15], s69 offen nt lds
  v_mfma_f32_16x16x32_bf16 v[252:255], v[84:87], v[52:55], v[252:255]
  s_waitcnt vmcnt(12)
  s_waitcnt lgkmcnt(0)
  s_barrier
  s_setprio 3
  ds_read_b128 v[56:59], v4 offset:0
  ds_read_b128 v[60:63], v4 offset:256
  ds_read_b128 v[64:67], v4 offset:512
  ds_read_b128 v[68:71], v4 offset:768
  ds_read_b128 v[72:75], v4 offset:4096
  ds_read_b128 v[76:79], v4 offset:4352
  ds_read_b128 v[80:83], v4 offset:4608
  ds_read_b128 v[84:87], v4 offset:4864
  s_add_u32 m0, s63, 0x0
  s_add_u32 s69, s62, 0x2c000
  buffer_load_dwordx4 v7, s[8:11], s69 offen nt lds
  s_add_u32 m0, s63, 0x2000
  s_add_u32 s69, s62, 0x2c000
  buffer_load_dwordx4 v8, s[12:15], s69 offen nt lds
  s_add_u32 m0, s63, 0x4000
  s_add_u32 s69, s62, 0x2e000
  buffer_load_dwordx4 v7, s[8:11], s69 offen nt lds
  s_add_u32 m0, s63, 0x6000
  s_add_u32 s69, s62, 0x2e000
  buffer_load_dwordx4 v8, s[12:15], s69 offen nt lds
  s_waitcnt lgkmcnt(7)
  v_mfma_f32_16x16x32_bf16 v[88:91], v[56:59], v[112:115], v[32:35]
  s_waitcnt lgkmcnt(6)
  v_mfma_f32_16x16x32_bf16 v[88:91], v[60:63], v[116:119], v[88:91]
  s_waitcnt lgkmcnt(5)
  v_mfma_f32_16x16x32_bf16 v[88:91], v[64:67], v[120:123], v[88:91]
  s_waitcnt lgkmcnt(4)
  v_mfma_f32_16x16x32_bf16 v[88:91], v[68:71], v[124:127], v[88:91]
  s_waitcnt lgkmcnt(3)
  v_mfma_f32_16x16x32_bf16 v[100:103], v[72:75], v[112:115], v[32:35]
  s_waitcnt lgkmcnt(2)
  v_mfma_f32_16x16x32_bf16 v[100:103], v[76:79], v[116:119], v[100:103]
  s_waitcnt lgkmcnt(1)
  v_mfma_f32_16x16x32_bf16 v[100:103], v[80:83], v[120:123], v[100:103]
  s_waitcnt lgkmcnt(0)
  v_mfma_f32_16x16x32_bf16 v[100:103], v[84:87], v[124:127], v[100:103]
  v_mfma_f32_16x16x32_bf16 v[92:95], v[56:59], v[128:131], v[36:39]
  v_exp_f32 v24, v88
  v_exp_f32 v25, v89
  v_mfma_f32_16x16x32_bf16 v[92:95], v[60:63], v[132:135], v[92:95]
  v_exp_f32 v26, v90
  v_exp_f32 v27, v91
  v_mfma_f32_16x16x32_bf16 v[92:95], v[64:67], v[136:139], v[92:95]
  v_add_f32 v12, v24, v25
  v_cvt_pk_bf16_f32 v44, v24, v25
  v_mfma_f32_16x16x32_bf16 v[92:95], v[68:71], v[140:143], v[92:95]
  v_add_f32 v12, v12, v26
  v_exp_f32 v28, v100
  v_mfma_f32_16x16x32_bf16 v[104:107], v[72:75], v[128:131], v[36:39]
  v_exp_f32 v29, v101
  v_cvt_pk_bf16_f32 v45, v26, v27
  v_mfma_f32_16x16x32_bf16 v[104:107], v[76:79], v[132:135], v[104:107]
  v_add_f32 v12, v12, v27
  v_exp_f32 v30, v102
  v_mfma_f32_16x16x32_bf16 v[104:107], v[80:83], v[136:139], v[104:107]
  v_exp_f32 v31, v103
  v_add_f32 v12, v12, v28
  v_mfma_f32_16x16x32_bf16 v[104:107], v[84:87], v[140:143], v[104:107]
  v_cvt_pk_bf16_f32 v46, v28, v29
  v_add_f32 v12, v12, v29
  v_mfma_f32_16x16x32_bf16 v[96:99], v[56:59], v[144:147], v[40:43]
  ds_read_b64_tr_b16 v[56:57], v5 offset:8192
  ds_read_b64_tr_b16 v[58:59], v5 offset:12288
  v_add_f32 v12, v12, v30
  v_cvt_pk_bf16_f32 v47, v30, v31
  v_add_f32 v12, v12, v31
  v_mfma_f32_16x16x32_bf16 v[96:99], v[60:63], v[148:151], v[96:99]
  ds_read_b64_tr_b16 v[60:61], v6 offset:8192
  ds_read_b64_tr_b16 v[62:63], v6 offset:12288
  v_cmp_lt_f32 vcc, s72, v12
  s_cbranch_vccz Lok_29
  s_swappc_b64 s[76:77], s[78:79]
Lok_29:
  v_add_f32 v9, v9, v12
  v_mfma_f32_16x16x32_bf16 v[96:99], v[64:67], v[152:155], v[96:99]
  ds_read_b64_tr_b16 v[64:65], v5 offset:8704
  ds_read_b64_tr_b16 v[66:67], v5 offset:12800
  v_exp_f32 v24, v92
  v_exp_f32 v25, v93
  v_mfma_f32_16x16x32_bf16 v[96:99], v[68:71], v[156:159], v[96:99]
  ds_read_b64_tr_b16 v[68:69], v6 offset:8704
  ds_read_b64_tr_b16 v[70:71], v6 offset:12800
  v_exp_f32 v26, v94
  v_exp_f32 v27, v95
  v_mfma_f32_16x16x32_bf16 v[108:111], v[72:75], v[144:147], v[40:43]
  ds_read_b64_tr_b16 v[72:73], v5 offset:9216
  ds_read_b64_tr_b16 v[74:75], v5 offset:13312
  v_add_f32 v13, v24, v25
  v_cvt_pk_bf16_f32 v48, v24, v25
  v_mfma_f32_16x16x32_bf16 v[108:111], v[76:79], v[148:151], v[108:111]
  ds_read_b64_tr_b16 v[76:77], v6 offset:9216
  ds_read_b64_tr_b16 v[78:79], v6 offset:13312
  v_add_f32 v13, v13, v26
  v_exp_f32 v28, v104
  v_mfma_f32_16x16x32_bf16 v[108:111], v[80:83], v[152:155], v[108:111]
  ds_read_b64_tr_b16 v[80:81], v5 offset:9728
  ds_read_b64_tr_b16 v[82:83], v5 offset:13824
  v_exp_f32 v29, v105
  v_cvt_pk_bf16_f32 v49, v26, v27
  v_mfma_f32_16x16x32_bf16 v[108:111], v[84:87], v[156:159], v[108:111]
  ds_read_b64_tr_b16 v[84:85], v6 offset:9728
  ds_read_b64_tr_b16 v[86:87], v6 offset:13824
  v_add_f32 v13, v13, v27
  v_exp_f32 v30, v106
  v_add_u32 v4, 0x10000, v4
  v_add_u32 v5, 0x10000, v5
  v_add_u32 v6, 0x10000, v6
  v_exp_f32 v31, v107
  v_add_f32 v13, v13, v28
  v_cvt_pk_bf16_f32 v50, v28, v29
  v_add_f32 v13, v13, v29
  v_add_f32 v13, v13, v30
  v_cvt_pk_bf16_f32 v51, v30, v31
  v_add_f32 v13, v13, v31
  v_cmp_lt_f32 vcc, s72, v13
  s_cbranch_vccz Lok_30
  s_swappc_b64 s[76:77], s[80:81]
Lok_30:
  v_add_f32 v10, v10, v13
  s_waitcnt vmcnt(12)
  s_waitcnt lgkmcnt(0)
  s_barrier
  s_setprio 0
  v_mfma_f32_16x16x32_bf16 v[160:163], v[56:59], v[44:47], v[160:163]
  v_exp_f32 v24, v96
  v_exp_f32 v25, v97
  v_mfma_f32_16x16x32_bf16 v[172:175], v[60:63], v[44:47], v[172:175]
  v_exp_f32 v26, v98
  v_mfma_f32_16x16x32_bf16 v[184:187], v[64:67], v[44:47], v[184:187]
  v_exp_f32 v27, v99
  v_mfma_f32_16x16x32_bf16 v[196:199], v[68:71], v[44:47], v[196:199]
  v_add_f32 v14, v24, v25
  v_cvt_pk_bf16_f32 v52, v24, v25
  v_mfma_f32_16x16x32_bf16 v[208:211], v[72:75], v[44:47], v[208:211]
  v_add_f32 v14, v14, v26
  v_mfma_f32_16x16x32_bf16 v[220:223], v[76:79], v[44:47], v[220:223]
  v_exp_f32 v28, v108
  v_mfma_f32_16x16x32_bf16 v[232:235], v[80:83], v[44:47], v[232:235]
  v_exp_f32 v29, v109
  v_cvt_pk_bf16_f32 v53, v26, v27
  v_mfma_f32_16x16x32_bf16 v[244:247], v[84:87], v[44:47], v[244:247]
  v_add_f32 v14, v14, v27
  v_mfma_f32_16x16x32_bf16 v[164:167], v[56:59], v[48:51], v[164:167]
  v_exp_f32 v30, v110
  v_mfma_f32_16x16x32_bf16 v[176:179], v[60:63], v[48:51], v[176:179]
  v_exp_f32 v31, v111
  v_add_f32 v14, v14, v28
  v_mfma_f32_16x16x32_bf16 v[188:191], v[64:67], v[48:51], v[188:191]
  v_cvt_pk_bf16_f32 v54, v28, v29
  v_mfma_f32_16x16x32_bf16 v[200:203], v[68:71], v[48:51], v[200:203]
  v_add_f32 v14, v14, v29
  v_mfma_f32_16x16x32_bf16 v[212:215], v[72:75], v[48:51], v[212:215]
  v_add_f32 v14, v14, v30
  v_cvt_pk_bf16_f32 v55, v30, v31
  v_mfma_f32_16x16x32_bf16 v[224:227], v[76:79], v[48:51], v[224:227]
  v_add_f32 v14, v14, v31
  v_mfma_f32_16x16x32_bf16 v[236:239], v[80:83], v[48:51], v[236:239]
  v_cmp_lt_f32 vcc, s72, v14
  s_cbranch_vccz Lok_31
  s_swappc_b64 s[76:77], s[82:83]
Lok_31:
  v_mfma_f32_16x16x32_bf16 v[248:251], v[84:87], v[48:51], v[248:251]
  v_add_f32 v11, v11, v14
  s_nop 1
  v_mfma_f32_16x16x32_bf16 v[168:171], v[56:59], v[52:55], v[168:171]
  s_add_u32 m0, s63, 0x8000
  s_add_u32 s69, s62, 0x30000
  buffer_load_dwordx4 v7, s[8:11], s69 offen nt lds
  v_mfma_f32_16x16x32_bf16 v[180:183], v[60:63], v[52:55], v[180:183]
  v_mfma_f32_16x16x32_bf16 v[192:195], v[64:67], v[52:55], v[192:195]
  s_add_u32 m0, s63, 0xa000
  s_add_u32 s69, s62, 0x30000
  buffer_load_dwordx4 v8, s[12:15], s69 offen nt lds
  v_mfma_f32_16x16x32_bf16 v[204:207], v[68:71], v[52:55], v[204:207]
  v_mfma_f32_16x16x32_bf16 v[216:219], v[72:75], v[52:55], v[216:219]
  s_add_u32 m0, s63, 0xc000
  s_add_u32 s69, s62, 0x32000
  buffer_load_dwordx4 v7, s[8:11], s69 offen nt lds
  v_mfma_f32_16x16x32_bf16 v[228:231], v[76:79], v[52:55], v[228:231]
  v_mfma_f32_16x16x32_bf16 v[240:243], v[80:83], v[52:55], v[240:243]
  s_add_u32 m0, s63, 0xe000
  s_add_u32 s69, s62, 0x32000
  buffer_load_dwordx4 v8, s[12:15], s69 offen nt lds
  v_mfma_f32_16x16x32_bf16 v[252:255], v[84:87], v[52:55], v[252:255]
  s_waitcnt vmcnt(12)
  s_waitcnt lgkmcnt(0)
  s_barrier
  s_setprio 3
  ds_read_b128 v[56:59], v4 offset:0
  ds_read_b128 v[60:63], v4 offset:256
  ds_read_b128 v[64:67], v4 offset:512
  ds_read_b128 v[68:71], v4 offset:768
  ds_read_b128 v[72:75], v4 offset:4096
  ds_read_b128 v[76:79], v4 offset:4352
  ds_read_b128 v[80:83], v4 offset:4608
  ds_read_b128 v[84:87], v4 offset:4864
  s_add_u32 m0, s63, 0x20000
  s_add_u32 s69, s62, 0x34000
  buffer_load_dwordx4 v7, s[8:11], s69 offen nt lds
  s_add_u32 m0, s63, 0x22000
  s_add_u32 s69, s62, 0x34000
  buffer_load_dwordx4 v8, s[12:15], s69 offen nt lds
  s_add_u32 m0, s63, 0x24000
  s_add_u32 s69, s62, 0x36000
  buffer_load_dwordx4 v7, s[8:11], s69 offen nt lds
  s_add_u32 m0, s63, 0x26000
  s_add_u32 s69, s62, 0x36000
  buffer_load_dwordx4 v8, s[12:15], s69 offen nt lds
  s_waitcnt lgkmcnt(7)
  v_mfma_f32_16x16x32_bf16 v[88:91], v[56:59], v[112:115], v[32:35]
  s_waitcnt lgkmcnt(6)
  v_mfma_f32_16x16x32_bf16 v[88:91], v[60:63], v[116:119], v[88:91]
  s_waitcnt lgkmcnt(5)
  v_mfma_f32_16x16x32_bf16 v[88:91], v[64:67], v[120:123], v[88:91]
  s_waitcnt lgkmcnt(4)
  v_mfma_f32_16x16x32_bf16 v[88:91], v[68:71], v[124:127], v[88:91]
  s_waitcnt lgkmcnt(3)
  v_mfma_f32_16x16x32_bf16 v[100:103], v[72:75], v[112:115], v[32:35]
  s_waitcnt lgkmcnt(2)
  v_mfma_f32_16x16x32_bf16 v[100:103], v[76:79], v[116:119], v[100:103]
  s_waitcnt lgkmcnt(1)
  v_mfma_f32_16x16x32_bf16 v[100:103], v[80:83], v[120:123], v[100:103]
  s_waitcnt lgkmcnt(0)
  v_mfma_f32_16x16x32_bf16 v[100:103], v[84:87], v[124:127], v[100:103]
  v_mfma_f32_16x16x32_bf16 v[92:95], v[56:59], v[128:131], v[36:39]
  v_exp_f32 v24, v88
  v_exp_f32 v25, v89
  v_mfma_f32_16x16x32_bf16 v[92:95], v[60:63], v[132:135], v[92:95]
  v_exp_f32 v26, v90
  v_exp_f32 v27, v91
  v_mfma_f32_16x16x32_bf16 v[92:95], v[64:67], v[136:139], v[92:95]
  v_add_f32 v12, v24, v25
  v_cvt_pk_bf16_f32 v44, v24, v25
  v_mfma_f32_16x16x32_bf16 v[92:95], v[68:71], v[140:143], v[92:95]
  v_add_f32 v12, v12, v26
  v_exp_f32 v28, v100
  v_mfma_f32_16x16x32_bf16 v[104:107], v[72:75], v[128:131], v[36:39]
  v_exp_f32 v29, v101
  v_cvt_pk_bf16_f32 v45, v26, v27
  v_mfma_f32_16x16x32_bf16 v[104:107], v[76:79], v[132:135], v[104:107]
  v_add_f32 v12, v12, v27
  v_exp_f32 v30, v102
  v_mfma_f32_16x16x32_bf16 v[104:107], v[80:83], v[136:139], v[104:107]
  v_exp_f32 v31, v103
  v_add_f32 v12, v12, v28
  v_mfma_f32_16x16x32_bf16 v[104:107], v[84:87], v[140:143], v[104:107]
  v_cvt_pk_bf16_f32 v46, v28, v29
  v_add_f32 v12, v12, v29
  v_mfma_f32_16x16x32_bf16 v[96:99], v[56:59], v[144:147], v[40:43]
  ds_read_b64_tr_b16 v[56:57], v5 offset:8192
  ds_read_b64_tr_b16 v[58:59], v5 offset:12288
  v_add_f32 v12, v12, v30
  v_cvt_pk_bf16_f32 v47, v30, v31
  v_add_f32 v12, v12, v31
  v_mfma_f32_16x16x32_bf16 v[96:99], v[60:63], v[148:151], v[96:99]
  ds_read_b64_tr_b16 v[60:61], v6 offset:8192
  ds_read_b64_tr_b16 v[62:63], v6 offset:12288
  v_cmp_lt_f32 vcc, s72, v12
  s_cbranch_vccz Lok_32
  s_swappc_b64 s[76:77], s[78:79]
Lok_32:
  v_add_f32 v9, v9, v12
  v_mfma_f32_16x16x32_bf16 v[96:99], v[64:67], v[152:155], v[96:99]
  ds_read_b64_tr_b16 v[64:65], v5 offset:8704
  ds_read_b64_tr_b16 v[66:67], v5 offset:12800
  v_exp_f32 v24, v92
  v_exp_f32 v25, v93
  v_mfma_f32_16x16x32_bf16 v[96:99], v[68:71], v[156:159], v[96:99]
  ds_read_b64_tr_b16 v[68:69], v6 offset:8704
  ds_read_b64_tr_b16 v[70:71], v6 offset:12800
  v_exp_f32 v26, v94
  v_exp_f32 v27, v95
  v_mfma_f32_16x16x32_bf16 v[108:111], v[72:75], v[144:147], v[40:43]
  ds_read_b64_tr_b16 v[72:73], v5 offset:9216
  ds_read_b64_tr_b16 v[74:75], v5 offset:13312
  v_add_f32 v13, v24, v25
  v_cvt_pk_bf16_f32 v48, v24, v25
  v_mfma_f32_16x16x32_bf16 v[108:111], v[76:79], v[148:151], v[108:111]
  ds_read_b64_tr_b16 v[76:77], v6 offset:9216
  ds_read_b64_tr_b16 v[78:79], v6 offset:13312
  v_add_f32 v13, v13, v26
  v_exp_f32 v28, v104
  v_mfma_f32_16x16x32_bf16 v[108:111], v[80:83], v[152:155], v[108:111]
  ds_read_b64_tr_b16 v[80:81], v5 offset:9728
  ds_read_b64_tr_b16 v[82:83], v5 offset:13824
  v_exp_f32 v29, v105
  v_cvt_pk_bf16_f32 v49, v26, v27
  v_mfma_f32_16x16x32_bf16 v[108:111], v[84:87], v[156:159], v[108:111]
  ds_read_b64_tr_b16 v[84:85], v6 offset:9728
  ds_read_b64_tr_b16 v[86:87], v6 offset:13824
  v_add_f32 v13, v13, v27
  v_exp_f32 v30, v106
  v_add_u32 v4, 0xfffe8000, v4
  v_add_u32 v5, 0xfffe8000, v5
  v_add_u32 v6, 0xfffe8000, v6
  v_exp_f32 v31, v107
  v_add_f32 v13, v13, v28
  v_cvt_pk_bf16_f32 v50, v28, v29
  v_add_f32 v13, v13, v29
  v_add_f32 v13, v13, v30
  v_cvt_pk_bf16_f32 v51, v30, v31
  v_add_f32 v13, v13, v31
  v_cmp_lt_f32 vcc, s72, v13
  s_cbranch_vccz Lok_33
  s_swappc_b64 s[76:77], s[80:81]
Lok_33:
  v_add_f32 v10, v10, v13
  s_waitcnt vmcnt(12)
  s_waitcnt lgkmcnt(0)
  s_barrier
  s_setprio 0
  v_mfma_f32_16x16x32_bf16 v[160:163], v[56:59], v[44:47], v[160:163]
  v_exp_f32 v24, v96
  v_exp_f32 v25, v97
  v_mfma_f32_16x16x32_bf16 v[172:175], v[60:63], v[44:47], v[172:175]
  v_exp_f32 v26, v98
  v_mfma_f32_16x16x32_bf16 v[184:187], v[64:67], v[44:47], v[184:187]
  v_exp_f32 v27, v99
  v_mfma_f32_16x16x32_bf16 v[196:199], v[68:71], v[44:47], v[196:199]
  v_add_f32 v14, v24, v25
  v_cvt_pk_bf16_f32 v52, v24, v25
  v_mfma_f32_16x16x32_bf16 v[208:211], v[72:75], v[44:47], v[208:211]
  v_add_f32 v14, v14, v26
  v_mfma_f32_16x16x32_bf16 v[220:223], v[76:79], v[44:47], v[220:223]
  v_exp_f32 v28, v108
  v_mfma_f32_16x16x32_bf16 v[232:235], v[80:83], v[44:47], v[232:235]
  v_exp_f32 v29, v109
  v_cvt_pk_bf16_f32 v53, v26, v27
  v_mfma_f32_16x16x32_bf16 v[244:247], v[84:87], v[44:47], v[244:247]
  v_add_f32 v14, v14, v27
  v_mfma_f32_16x16x32_bf16 v[164:167], v[56:59], v[48:51], v[164:167]
  v_exp_f32 v30, v110
  v_mfma_f32_16x16x32_bf16 v[176:179], v[60:63], v[48:51], v[176:179]
  v_exp_f32 v31, v111
  v_add_f32 v14, v14, v28
  v_mfma_f32_16x16x32_bf16 v[188:191], v[64:67], v[48:51], v[188:191]
  v_cvt_pk_bf16_f32 v54, v28, v29
  v_mfma_f32_16x16x32_bf16 v[200:203], v[68:71], v[48:51], v[200:203]
  v_add_f32 v14, v14, v29
  v_mfma_f32_16x16x32_bf16 v[212:215], v[72:75], v[48:51], v[212:215]
  v_add_f32 v14, v14, v30
  v_cvt_pk_bf16_f32 v55, v30, v31
  v_mfma_f32_16x16x32_bf16 v[224:227], v[76:79], v[48:51], v[224:227]
  v_add_f32 v14, v14, v31
  v_mfma_f32_16x16x32_bf16 v[236:239], v[80:83], v[48:51], v[236:239]
  v_cmp_lt_f32 vcc, s72, v14
  s_cbranch_vccz Lok_34
  s_swappc_b64 s[76:77], s[82:83]
Lok_34:
  v_mfma_f32_16x16x32_bf16 v[248:251], v[84:87], v[48:51], v[248:251]
  v_add_f32 v11, v11, v14
  s_nop 1
  v_mfma_f32_16x16x32_bf16 v[168:171], v[56:59], v[52:55], v[168:171]
  s_add_u32 m0, s63, 0x18000
  s_add_u32 s69, s62, 0x38000
  buffer_load_dwordx4 v7, s[8:11], s69 offen nt lds
  v_mfma_f32_16x16x32_bf16 v[180:183], v[60:63], v[52:55], v[180:183]
  v_mfma_f32_16x16x32_bf16 v[192:195], v[64:67], v[52:55], v[192:195]
  s_add_u32 m0, s63, 0x1a000
  s_add_u32 s69, s62, 0x38000
  buffer_load_dwordx4 v8, s[12:15], s69 offen nt lds
  v_mfma_f32_16x16x32_bf16 v[204:207], v[68:71], v[52:55], v[204:207]
  v_mfma_f32_16x16x32_bf16 v[216:219], v[72:75], v[52:55], v[216:219]
  s_add_u32 m0, s63, 0x1c000
  s_add_u32 s69, s62, 0x3a000
  buffer_load_dwordx4 v7, s[8:11], s69 offen nt lds
  v_mfma_f32_16x16x32_bf16 v[228:231], v[76:79], v[52:55], v[228:231]
  v_mfma_f32_16x16x32_bf16 v[240:243], v[80:83], v[52:55], v[240:243]
  s_add_u32 m0, s63, 0x1e000
  s_add_u32 s69, s62, 0x3a000
  buffer_load_dwordx4 v8, s[12:15], s69 offen nt lds
  v_mfma_f32_16x16x32_bf16 v[252:255], v[84:87], v[52:55], v[252:255]
  s_waitcnt vmcnt(12)
  s_waitcnt lgkmcnt(0)
  s_barrier
  s_setprio 3
  ds_read_b128 v[56:59], v4 offset:0
  ds_read_b128 v[60:63], v4 offset:256
  ds_read_b128 v[64:67], v4 offset:512
  ds_read_b128 v[68:71], v4 offset:768
  ds_read_b128 v[72:75], v4 offset:4096
  ds_read_b128 v[76:79], v4 offset:4352
  ds_read_b128 v[80:83], v4 offset:4608
  ds_read_b128 v[84:87], v4 offset:4864
  s_add_u32 m0, s63, 0x10000
  s_add_u32 s69, s62, 0x3c000
  buffer_load_dwordx4 v7, s[8:11], s69 offen nt lds
  s_add_u32 m0, s63, 0x12000
  s_add_u32 s69, s62, 0x3c000
  buffer_load_dwordx4 v8, s[12:15], s69 offen nt lds
  s_add_u32 m0, s63, 0x14000
  s_add_u32 s69, s62, 0x3e000
  buffer_load_dwordx4 v7, s[8:11], s69 offen nt lds
  s_add_u32 m0, s63, 0x16000
  s_add_u32 s69, s62, 0x3e000
  buffer_load_dwordx4 v8, s[12:15], s69 offen nt lds
  s_waitcnt lgkmcnt(7)
  v_mfma_f32_16x16x32_bf16 v[88:91], v[56:59], v[112:115], v[32:35]
  s_waitcnt lgkmcnt(6)
  v_mfma_f32_16x16x32_bf16 v[88:91], v[60:63], v[116:119], v[88:91]
  s_waitcnt lgkmcnt(5)
  v_mfma_f32_16x16x32_bf16 v[88:91], v[64:67], v[120:123], v[88:91]
  s_waitcnt lgkmcnt(4)
  v_mfma_f32_16x16x32_bf16 v[88:91], v[68:71], v[124:127], v[88:91]
  s_waitcnt lgkmcnt(3)
  v_mfma_f32_16x16x32_bf16 v[100:103], v[72:75], v[112:115], v[32:35]
  s_waitcnt lgkmcnt(2)
  v_mfma_f32_16x16x32_bf16 v[100:103], v[76:79], v[116:119], v[100:103]
  s_waitcnt lgkmcnt(1)
  v_mfma_f32_16x16x32_bf16 v[100:103], v[80:83], v[120:123], v[100:103]
  s_waitcnt lgkmcnt(0)
  v_mfma_f32_16x16x32_bf16 v[100:103], v[84:87], v[124:127], v[100:103]
  v_mfma_f32_16x16x32_bf16 v[92:95], v[56:59], v[128:131], v[36:39]
  v_exp_f32 v24, v88
  v_exp_f32 v25, v89
  v_mfma_f32_16x16x32_bf16 v[92:95], v[60:63], v[132:135], v[92:95]
  v_exp_f32 v26, v90
  v_exp_f32 v27, v91
  v_mfma_f32_16x16x32_bf16 v[92:95], v[64:67], v[136:139], v[92:95]
  v_add_f32 v12, v24, v25
  v_cvt_pk_bf16_f32 v44, v24, v25
  v_mfma_f32_16x16x32_bf16 v[92:95], v[68:71], v[140:143], v[92:95]
  v_add_f32 v12, v12, v26
  v_exp_f32 v28, v100
  v_mfma_f32_16x16x32_bf16 v[104:107], v[72:75], v[128:131], v[36:39]
  v_exp_f32 v29, v101
  v_cvt_pk_bf16_f32 v45, v26, v27
  v_mfma_f32_16x16x32_bf16 v[104:107], v[76:79], v[132:135], v[104:107]
  v_add_f32 v12, v12, v27
  v_exp_f32 v30, v102
  v_mfma_f32_16x16x32_bf16 v[104:107], v[80:83], v[136:139], v[104:107]
  v_exp_f32 v31, v103
  v_add_f32 v12, v12, v28
  v_mfma_f32_16x16x32_bf16 v[104:107], v[84:87], v[140:143], v[104:107]
  v_cvt_pk_bf16_f32 v46, v28, v29
  v_add_f32 v12, v12, v29
  v_mfma_f32_16x16x32_bf16 v[96:99], v[56:59], v[144:147], v[40:43]
  ds_read_b64_tr_b16 v[56:57], v5 offset:8192
  ds_read_b64_tr_b16 v[58:59], v5 offset:12288
  v_add_f32 v12, v12, v30
  v_cvt_pk_bf16_f32 v47, v30, v31
  v_add_f32 v12, v12, v31
  v_mfma_f32_16x16x32_bf16 v[96:99], v[60:63], v[148:151], v[96:99]
  ds_read_b64_tr_b16 v[60:61], v6 offset:8192
  ds_read_b64_tr_b16 v[62:63], v6 offset:12288
  v_cmp_lt_f32 vcc, s72, v12
  s_cbranch_vccz Lok_35
  s_swappc_b64 s[76:77], s[78:79]
Lok_35:
  v_add_f32 v9, v9, v12
  v_mfma_f32_16x16x32_bf16 v[96:99], v[64:67], v[152:155], v[96:99]
  ds_read_b64_tr_b16 v[64:65], v5 offset:8704
  ds_read_b64_tr_b16 v[66:67], v5 offset:12800
  v_exp_f32 v24, v92
  v_exp_f32 v25, v93
  v_mfma_f32_16x16x32_bf16 v[96:99], v[68:71], v[156:159], v[96:99]
  ds_read_b64_tr_b16 v[68:69], v6 offset:8704
  ds_read_b64_tr_b16 v[70:71], v6 offset:12800
  v_exp_f32 v26, v94
  v_exp_f32 v27, v95
  v_mfma_f32_16x16x32_bf16 v[108:111], v[72:75], v[144:147], v[40:43]
  ds_read_b64_tr_b16 v[72:73], v5 offset:9216
  ds_read_b64_tr_b16 v[74:75], v5 offset:13312
  v_add_f32 v13, v24, v25
  v_cvt_pk_bf16_f32 v48, v24, v25
  v_mfma_f32_16x16x32_bf16 v[108:111], v[76:79], v[148:151], v[108:111]
  ds_read_b64_tr_b16 v[76:77], v6 offset:9216
  ds_read_b64_tr_b16 v[78:79], v6 offset:13312
  v_add_f32 v13, v13, v26
  v_exp_f32 v28, v104
  v_mfma_f32_16x16x32_bf16 v[108:111], v[80:83], v[152:155], v[108:111]
  ds_read_b64_tr_b16 v[80:81], v5 offset:9728
  ds_read_b64_tr_b16 v[82:83], v5 offset:13824
  v_exp_f32 v29, v105
  v_cvt_pk_bf16_f32 v49, v26, v27
  v_mfma_f32_16x16x32_bf16 v[108:111], v[84:87], v[156:159], v[108:111]
  ds_read_b64_tr_b16 v[84:85], v6 offset:9728
  ds_read_b64_tr_b16 v[86:87], v6 offset:13824
  v_add_f32 v13, v13, v27
  v_exp_f32 v30, v106
  v_add_u32 v4, 0x20000, v4
  v_add_u32 v5, 0x20000, v5
  v_add_u32 v6, 0x20000, v6
  v_exp_f32 v31, v107
  v_add_f32 v13, v13, v28
  v_cvt_pk_bf16_f32 v50, v28, v29
  v_add_f32 v13, v13, v29
  v_add_f32 v13, v13, v30
  v_cvt_pk_bf16_f32 v51, v30, v31
  v_add_f32 v13, v13, v31
  v_cmp_lt_f32 vcc, s72, v13
  s_cbranch_vccz Lok_36
  s_swappc_b64 s[76:77], s[80:81]
Lok_36:
  v_add_f32 v10, v10, v13
  s_waitcnt vmcnt(12)
  s_waitcnt lgkmcnt(0)
  s_barrier
  s_setprio 0
  v_mfma_f32_16x16x32_bf16 v[160:163], v[56:59], v[44:47], v[160:163]
  v_exp_f32 v24, v96
  v_exp_f32 v25, v97
  v_mfma_f32_16x16x32_bf16 v[172:175], v[60:63], v[44:47], v[172:175]
  v_exp_f32 v26, v98
  v_mfma_f32_16x16x32_bf16 v[184:187], v[64:67], v[44:47], v[184:187]
  v_exp_f32 v27, v99
  v_mfma_f32_16x16x32_bf16 v[196:199], v[68:71], v[44:47], v[196:199]
  v_add_f32 v14, v24, v25
  v_cvt_pk_bf16_f32 v52, v24, v25
  v_mfma_f32_16x16x32_bf16 v[208:211], v[72:75], v[44:47], v[208:211]
  v_add_f32 v14, v14, v26
  v_mfma_f32_16x16x32_bf16 v[220:223], v[76:79], v[44:47], v[220:223]
  v_exp_f32 v28, v108
  v_mfma_f32_16x16x32_bf16 v[232:235], v[80:83], v[44:47], v[232:235]
  v_exp_f32 v29, v109
  v_cvt_pk_bf16_f32 v53, v26, v27
  v_mfma_f32_16x16x32_bf16 v[244:247], v[84:87], v[44:47], v[244:247]
  v_add_f32 v14, v14, v27
  v_mfma_f32_16x16x32_bf16 v[164:167], v[56:59], v[48:51], v[164:167]
  v_exp_f32 v30, v110
  v_mfma_f32_16x16x32_bf16 v[176:179], v[60:63], v[48:51], v[176:179]
  v_exp_f32 v31, v111
  v_add_f32 v14, v14, v28
  v_mfma_f32_16x16x32_bf16 v[188:191], v[64:67], v[48:51], v[188:191]
  v_cvt_pk_bf16_f32 v54, v28, v29
  v_mfma_f32_16x16x32_bf16 v[200:203], v[68:71], v[48:51], v[200:203]
  v_add_f32 v14, v14, v29
  v_mfma_f32_16x16x32_bf16 v[212:215], v[72:75], v[48:51], v[212:215]
  v_add_f32 v14, v14, v30
  v_cvt_pk_bf16_f32 v55, v30, v31
  v_mfma_f32_16x16x32_bf16 v[224:227], v[76:79], v[48:51], v[224:227]
  v_add_f32 v14, v14, v31
  v_mfma_f32_16x16x32_bf16 v[236:239], v[80:83], v[48:51], v[236:239]
  v_cmp_lt_f32 vcc, s72, v14
  s_cbranch_vccz Lok_37
  s_swappc_b64 s[76:77], s[82:83]
Lok_37:
  v_mfma_f32_16x16x32_bf16 v[248:251], v[84:87], v[48:51], v[248:251]
  v_add_f32 v11, v11, v14
  s_nop 1
  v_mfma_f32_16x16x32_bf16 v[168:171], v[56:59], v[52:55], v[168:171]
  s_add_u32 m0, s63, 0x0
  s_add_u32 s69, s73, 0x0
  buffer_load_dwordx4 v20, s[20:23], s69 offen  lds
  v_mfma_f32_16x16x32_bf16 v[180:183], v[60:63], v[52:55], v[180:183]
  v_mfma_f32_16x16x32_bf16 v[192:195], v[64:67], v[52:55], v[192:195]
  s_add_u32 m0, s63, 0x2000
  s_add_u32 s69, s73, 0x8000
  buffer_load_dwordx4 v20, s[20:23], s69 offen  lds
  v_mfma_f32_16x16x32_bf16 v[204:207], v[68:71], v[52:55], v[204:207]
  v_mfma_f32_16x16x32_bf16 v[216:219], v[72:75], v[52:55], v[216:219]
  s_add_u32 m0, s63, 0x4000
  s_add_u32 s69, s73, 0x10000
  buffer_load_dwordx4 v20, s[20:23], s69 offen  lds
  v_mfma_f32_16x16x32_bf16 v[228:231], v[76:79], v[52:55], v[228:231]
  v_mfma_f32_16x16x32_bf16 v[240:243], v[80:83], v[52:55], v[240:243]
  s_add_u32 m0, s63, 0x6000
  s_add_u32 s69, s73, 0x18000
  buffer_load_dwordx4 v20, s[20:23], s69 offen  lds
  v_mfma_f32_16x16x32_bf16 v[252:255], v[84:87], v[52:55], v[252:255]
  s_waitcnt vmcnt(12)
  s_waitcnt lgkmcnt(0)
  s_barrier
  s_setprio 3
  ds_read_b128 v[56:59], v4 offset:0
  ds_read_b128 v[60:63], v4 offset:256
  ds_read_b128 v[64:67], v4 offset:512
  ds_read_b128 v[68:71], v4 offset:768
  ds_read_b128 v[72:75], v4 offset:4096
  ds_read_b128 v[76:79], v4 offset:4352
  ds_read_b128 v[80:83], v4 offset:4608
  ds_read_b128 v[84:87], v4 offset:4864
  s_add_u32 m0, s63, 0x8000
  s_add_u32 s69, s73, 0x20000
  buffer_load_dwordx4 v20, s[20:23], s69 offen  lds
  s_add_u32 m0, s63, 0xa000
  s_add_u32 s69, s73, 0x28000
  buffer_load_dwordx4 v20, s[20:23], s69 offen  lds
  s_add_u32 m0, s63, 0xc000
  s_add_u32 s69, s73, 0x30000
  buffer_load_dwordx4 v20, s[20:23], s69 offen  lds
  s_add_u32 m0, s63, 0xe000
  s_add_u32 s69, s73, 0x38000
  buffer_load_dwordx4 v20, s[20:23], s69 offen  lds
  s_waitcnt lgkmcnt(7)
  v_mfma_f32_16x16x32_bf16 v[88:91], v[56:59], v[112:115], v[32:35]
  s_waitcnt lgkmcnt(6)
  v_mfma_f32_16x16x32_bf16 v[88:91], v[60:63], v[116:119], v[88:91]
  s_waitcnt lgkmcnt(5)
  v_mfma_f32_16x16x32_bf16 v[88:91], v[64:67], v[120:123], v[88:91]
  s_waitcnt lgkmcnt(4)
  v_mfma_f32_16x16x32_bf16 v[88:91], v[68:71], v[124:127], v[88:91]
  s_waitcnt lgkmcnt(3)
  v_mfma_f32_16x16x32_bf16 v[100:103], v[72:75], v[112:115], v[32:35]
  s_waitcnt lgkmcnt(2)
  v_mfma_f32_16x16x32_bf16 v[100:103], v[76:79], v[116:119], v[100:103]
  s_waitcnt lgkmcnt(1)
  v_mfma_f32_16x16x32_bf16 v[100:103], v[80:83], v[120:123], v[100:103]
  s_waitcnt lgkmcnt(0)
  v_mfma_f32_16x16x32_bf16 v[100:103], v[84:87], v[124:127], v[100:103]
  v_mfma_f32_16x16x32_bf16 v[92:95], v[56:59], v[128:131], v[36:39]
  v_exp_f32 v24, v88
  v_exp_f32 v25, v89
  v_mfma_f32_16x16x32_bf16 v[92:95], v[60:63], v[132:135], v[92:95]
  v_exp_f32 v26, v90
  v_exp_f32 v27, v91
  v_mfma_f32_16x16x32_bf16 v[92:95], v[64:67], v[136:139], v[92:95]
  v_add_f32 v12, v24, v25
  v_cvt_pk_bf16_f32 v44, v24, v25
  v_mfma_f32_16x16x32_bf16 v[92:95], v[68:71], v[140:143], v[92:95]
  v_add_f32 v12, v12, v26
  v_exp_f32 v28, v100
  v_mfma_f32_16x16x32_bf16 v[104:107], v[72:75], v[128:131], v[36:39]
  v_exp_f32 v29, v101
  v_cvt_pk_bf16_f32 v45, v26, v27
  v_mfma_f32_16x16x32_bf16 v[104:107], v[76:79], v[132:135], v[104:107]
  v_add_f32 v12, v12, v27
  v_exp_f32 v30, v102
  v_mfma_f32_16x16x32_bf16 v[104:107], v[80:83], v[136:139], v[104:107]
  v_exp_f32 v31, v103
  v_add_f32 v12, v12, v28
  v_mfma_f32_16x16x32_bf16 v[104:107], v[84:87], v[140:143], v[104:107]
  v_cvt_pk_bf16_f32 v46, v28, v29
  v_add_f32 v12, v12, v29
  v_mfma_f32_16x16x32_bf16 v[96:99], v[56:59], v[144:147], v[40:43]
  ds_read_b64_tr_b16 v[56:57], v5 offset:8192
  ds_read_b64_tr_b16 v[58:59], v5 offset:12288
  v_add_f32 v12, v12, v30
  v_cvt_pk_bf16_f32 v47, v30, v31
  v_add_f32 v12, v12, v31
  v_mfma_f32_16x16x32_bf16 v[96:99], v[60:63], v[148:151], v[96:99]
  ds_read_b64_tr_b16 v[60:61], v6 offset:8192
  ds_read_b64_tr_b16 v[62:63], v6 offset:12288
  v_cmp_lt_f32 vcc, s72, v12
  s_cbranch_vccz Lok_38
  s_swappc_b64 s[76:77], s[78:79]
Lok_38:
  v_add_f32 v9, v9, v12
  v_mfma_f32_16x16x32_bf16 v[96:99], v[64:67], v[152:155], v[96:99]
  ds_read_b64_tr_b16 v[64:65], v5 offset:8704
  ds_read_b64_tr_b16 v[66:67], v5 offset:12800
  v_exp_f32 v24, v92
  v_exp_f32 v25, v93
  v_mfma_f32_16x16x32_bf16 v[96:99], v[68:71], v[156:159], v[96:99]
  ds_read_b64_tr_b16 v[68:69], v6 offset:8704
  ds_read_b64_tr_b16 v[70:71], v6 offset:12800
  v_exp_f32 v26, v94
  v_exp_f32 v27, v95
  v_mfma_f32_16x16x32_bf16 v[108:111], v[72:75], v[144:147], v[40:43]
  ds_read_b64_tr_b16 v[72:73], v5 offset:9216
  ds_read_b64_tr_b16 v[74:75], v5 offset:13312
  v_add_f32 v13, v24, v25
  v_cvt_pk_bf16_f32 v48, v24, v25
  v_mfma_f32_16x16x32_bf16 v[108:111], v[76:79], v[148:151], v[108:111]
  ds_read_b64_tr_b16 v[76:77], v6 offset:9216
  ds_read_b64_tr_b16 v[78:79], v6 offset:13312
  v_add_f32 v13, v13, v26
  v_exp_f32 v28, v104
  v_mfma_f32_16x16x32_bf16 v[108:111], v[80:83], v[152:155], v[108:111]
  ds_read_b64_tr_b16 v[80:81], v5 offset:9728
  ds_read_b64_tr_b16 v[82:83], v5 offset:13824
  v_exp_f32 v29, v105
  v_cvt_pk_bf16_f32 v49, v26, v27
  v_mfma_f32_16x16x32_bf16 v[108:111], v[84:87], v[156:159], v[108:111]
  ds_read_b64_tr_b16 v[84:85], v6 offset:9728
  ds_read_b64_tr_b16 v[86:87], v6 offset:13824
  v_add_f32 v13, v13, v27
  v_exp_f32 v30, v106
  v_add_u32 v4, 0xffff0000, v4
  v_add_u32 v5, 0xffff0000, v5
  v_add_u32 v6, 0xffff0000, v6
  v_exp_f32 v31, v107
  v_add_f32 v13, v13, v28
  v_cvt_pk_bf16_f32 v50, v28, v29
  v_add_f32 v13, v13, v29
  v_add_f32 v13, v13, v30
  v_cvt_pk_bf16_f32 v51, v30, v31
  v_add_f32 v13, v13, v31
  v_cmp_lt_f32 vcc, s72, v13
  s_cbranch_vccz Lok_39
  s_swappc_b64 s[76:77], s[80:81]
Lok_39:
  v_add_f32 v10, v10, v13
  s_waitcnt vmcnt(12)
  s_waitcnt lgkmcnt(0)
  s_barrier
  s_setprio 0
  v_mfma_f32_16x16x32_bf16 v[160:163], v[56:59], v[44:47], v[160:163]
  v_exp_f32 v24, v96
  v_exp_f32 v25, v97
  v_mfma_f32_16x16x32_bf16 v[172:175], v[60:63], v[44:47], v[172:175]
  v_exp_f32 v26, v98
  v_mfma_f32_16x16x32_bf16 v[184:187], v[64:67], v[44:47], v[184:187]
  v_exp_f32 v27, v99
  v_mfma_f32_16x16x32_bf16 v[196:199], v[68:71], v[44:47], v[196:199]
  v_add_f32 v14, v24, v25
  v_cvt_pk_bf16_f32 v52, v24, v25
  v_mfma_f32_16x16x32_bf16 v[208:211], v[72:75], v[44:47], v[208:211]
  v_add_f32 v14, v14, v26
  v_mfma_f32_16x16x32_bf16 v[220:223], v[76:79], v[44:47], v[220:223]
  v_exp_f32 v28, v108
  v_mfma_f32_16x16x32_bf16 v[232:235], v[80:83], v[44:47], v[232:235]
  v_exp_f32 v29, v109
  v_cvt_pk_bf16_f32 v53, v26, v27
  v_mfma_f32_16x16x32_bf16 v[244:247], v[84:87], v[44:47], v[244:247]
  v_add_f32 v14, v14, v27
  v_mfma_f32_16x16x32_bf16 v[164:167], v[56:59], v[48:51], v[164:167]
  v_exp_f32 v30, v110
  v_mfma_f32_16x16x32_bf16 v[176:179], v[60:63], v[48:51], v[176:179]
  v_exp_f32 v31, v111
  v_add_f32 v14, v14, v28
  v_mfma_f32_16x16x32_bf16 v[188:191], v[64:67], v[48:51], v[188:191]
  v_cvt_pk_bf16_f32 v54, v28, v29
  v_mfma_f32_16x16x32_bf16 v[200:203], v[68:71], v[48:51], v[200:203]
  v_add_f32 v14, v14, v29
  v_mfma_f32_16x16x32_bf16 v[212:215], v[72:75], v[48:51], v[212:215]
  v_add_f32 v14, v14, v30
  v_cvt_pk_bf16_f32 v55, v30, v31
  v_mfma_f32_16x16x32_bf16 v[224:227], v[76:79], v[48:51], v[224:227]
  v_add_f32 v14, v14, v31
  v_mfma_f32_16x16x32_bf16 v[236:239], v[80:83], v[48:51], v[236:239]
  v_cmp_lt_f32 vcc, s72, v14
  s_cbranch_vccz Lok_40
  s_swappc_b64 s[76:77], s[82:83]
Lok_40:
  v_mfma_f32_16x16x32_bf16 v[248:251], v[84:87], v[48:51], v[248:251]
  v_add_f32 v11, v11, v14
  s_nop 1
  v_mfma_f32_16x16x32_bf16 v[168:171], v[56:59], v[52:55], v[168:171]
  s_add_u32 m0, s63, 0x20000
  s_add_u32 s69, s73, 0x40000
  buffer_load_dwordx4 v20, s[20:23], s69 offen  lds
  v_mfma_f32_16x16x32_bf16 v[180:183], v[60:63], v[52:55], v[180:183]
  v_mfma_f32_16x16x32_bf16 v[192:195], v[64:67], v[52:55], v[192:195]
  s_add_u32 m0, s63, 0x22000
  s_add_u32 s69, s73, 0x48000
  buffer_load_dwordx4 v20, s[20:23], s69 offen  lds
  v_mfma_f32_16x16x32_bf16 v[204:207], v[68:71], v[52:55], v[204:207]
  v_mfma_f32_16x16x32_bf16 v[216:219], v[72:75], v[52:55], v[216:219]
  s_add_u32 m0, s63, 0x24000
  s_add_u32 s69, s73, 0x50000
  buffer_load_dwordx4 v20, s[20:23], s69 offen  lds
  v_mfma_f32_16x16x32_bf16 v[228:231], v[76:79], v[52:55], v[228:231]
  v_mfma_f32_16x16x32_bf16 v[240:243], v[80:83], v[52:55], v[240:243]
  s_add_u32 m0, s63, 0x26000
  s_add_u32 s69, s73, 0x58000
  buffer_load_dwordx4 v20, s[20:23], s69 offen  lds
  v_mfma_f32_16x16x32_bf16 v[252:255], v[84:87], v[52:55], v[252:255]
  s_waitcnt vmcnt(12)
  s_waitcnt lgkmcnt(0)
  s_barrier
  s_setprio 3
  ds_read_b128 v[56:59], v4 offset:0
  ds_read_b128 v[60:63], v4 offset:256
  ds_read_b128 v[64:67], v4 offset:512
  ds_read_b128 v[68:71], v4 offset:768
  ds_read_b128 v[72:75], v4 offset:4096
  ds_read_b128 v[76:79], v4 offset:4352
  ds_read_b128 v[80:83], v4 offset:4608
  ds_read_b128 v[84:87], v4 offset:4864
  v_lshlrev_b32 v21, 7, v1
  s_lshl_b32 s69, s2, 3
  s_add_u32 s69, s69, s56
  s_mul_i32 s69, s69, 3584
  s_bfm_b64 exec, 27, 0
  buffer_load_dword v17, v21, s[32:35], s69 offen offset:0
  s_mov_b64 exec, -1
  s_nop 3
  s_nop 0
  s_add_u32 m0, s63, 0x18000
  s_add_u32 s69, s73, 0x60000
  buffer_load_dwordx4 v20, s[20:23], s69 offen  lds
  s_add_u32 m0, s63, 0x1a000
  s_add_u32 s69, s73, 0x68000
  buffer_load_dwordx4 v20, s[20:23], s69 offen  lds
  s_add_u32 m0, s63, 0x1c000
  s_add_u32 s69, s73, 0x70000
  buffer_load_dwordx4 v20, s[20:23], s69 offen  lds
  s_add_u32 m0, s63, 0x1e000
  s_add_u32 s69, s73, 0x78000
  buffer_load_dwordx4 v20, s[20:23], s69 offen  lds
  s_waitcnt lgkmcnt(7)
  v_mfma_f32_16x16x32_bf16 v[88:91], v[56:59], v[112:115], v[32:35]
  s_waitcnt lgkmcnt(6)
  v_mfma_f32_16x16x32_bf16 v[88:91], v[60:63], v[116:119], v[88:91]
  s_waitcnt lgkmcnt(5)
  v_mfma_f32_16x16x32_bf16 v[88:91], v[64:67], v[120:123], v[88:91]
  s_waitcnt lgkmcnt(4)
  v_mfma_f32_16x16x32_bf16 v[88:91], v[68:71], v[124:127], v[88:91]
  s_waitcnt lgkmcnt(3)
  v_mfma_f32_16x16x32_bf16 v[100:103], v[72:75], v[112:115], v[32:35]
  s_waitcnt lgkmcnt(2)
  v_mfma_f32_16x16x32_bf16 v[100:103], v[76:79], v[116:119], v[100:103]
  s_waitcnt lgkmcnt(1)
  v_mfma_f32_16x16x32_bf16 v[100:103], v[80:83], v[120:123], v[100:103]
  s_waitcnt lgkmcnt(0)
  v_mfma_f32_16x16x32_bf16 v[100:103], v[84:87], v[124:127], v[100:103]
  v_mfma_f32_16x16x32_bf16 v[92:95], v[56:59], v[128:131], v[36:39]
  v_exp_f32 v24, v88
  v_exp_f32 v25, v89
  v_mfma_f32_16x16x32_bf16 v[92:95], v[60:63], v[132:135], v[92:95]
  v_exp_f32 v26, v90
  v_exp_f32 v27, v91
  v_mfma_f32_16x16x32_bf16 v[92:95], v[64:67], v[136:139], v[92:95]
  v_add_f32 v12, v24, v25
  v_cvt_pk_bf16_f32 v44, v24, v25
  v_mfma_f32_16x16x32_bf16 v[92:95], v[68:71], v[140:143], v[92:95]
  v_add_f32 v12, v12, v26
  v_exp_f32 v28, v100
  v_mfma_f32_16x16x32_bf16 v[104:107], v[72:75], v[128:131], v[36:39]
  v_exp_f32 v29, v101
  v_cvt_pk_bf16_f32 v45, v26, v27
  v_mfma_f32_16x16x32_bf16 v[104:107], v[76:79], v[132:135], v[104:107]
  v_add_f32 v12, v12, v27
  v_exp_f32 v30, v102
  v_mfma_f32_16x16x32_bf16 v[104:107], v[80:83], v[136:139], v[104:107]
  v_exp_f32 v31, v103
  v_add_f32 v12, v12, v28
  v_mfma_f32_16x16x32_bf16 v[104:107], v[84:87], v[140:143], v[104:107]
  v_cvt_pk_bf16_f32 v46, v28, v29
  v_add_f32 v12, v12, v29
  v_mfma_f32_16x16x32_bf16 v[96:99], v[56:59], v[144:147], v[40:43]
  ds_read_b64_tr_b16 v[56:57], v5 offset:8192
  ds_read_b64_tr_b16 v[58:59], v5 offset:12288
  v_add_f32 v12, v12, v30
  v_cvt_pk_bf16_f32 v47, v30, v31
  v_add_f32 v12, v12, v31
  v_mfma_f32_16x16x32_bf16 v[96:99], v[60:63], v[148:151], v[96:99]
  ds_read_b64_tr_b16 v[60:61], v6 offset:8192
  ds_read_b64_tr_b16 v[62:63], v6 offset:12288
  v_cmp_lt_f32 vcc, s72, v12
  s_cbranch_vccz Lok_41
  s_swappc_b64 s[76:77], s[78:79]
Lok_41:
  v_add_f32 v9, v9, v12
  v_mfma_f32_16x16x32_bf16 v[96:99], v[64:67], v[152:155], v[96:99]
  ds_read_b64_tr_b16 v[64:65], v5 offset:8704
  ds_read_b64_tr_b16 v[66:67], v5 offset:12800
  v_exp_f32 v24, v92
  v_exp_f32 v25, v93
  v_mfma_f32_16x16x32_bf16 v[96:99], v[68:71], v[156:159], v[96:99]
  ds_read_b64_tr_b16 v[68:69], v6 offset:8704
  ds_read_b64_tr_b16 v[70:71], v6 offset:12800
  v_exp_f32 v26, v94
  v_exp_f32 v27, v95
  v_mfma_f32_16x16x32_bf16 v[108:111], v[72:75], v[144:147], v[40:43]
  ds_read_b64_tr_b16 v[72:73], v5 offset:9216
  ds_read_b64_tr_b16 v[74:75], v5 offset:13312
  v_add_f32 v13, v24, v25
  v_cvt_pk_bf16_f32 v48, v24, v25
  v_mfma_f32_16x16x32_bf16 v[108:111], v[76:79], v[148:151], v[108:111]
  ds_read_b64_tr_b16 v[76:77], v6 offset:9216
  ds_read_b64_tr_b16 v[78:79], v6 offset:13312
  v_add_f32 v13, v13, v26
  v_exp_f32 v28, v104
  v_mfma_f32_16x16x32_bf16 v[108:111], v[80:83], v[152:155], v[108:111]
  ds_read_b64_tr_b16 v[80:81], v5 offset:9728
  ds_read_b64_tr_b16 v[82:83], v5 offset:13824
  v_exp_f32 v29, v105
  v_cvt_pk_bf16_f32 v49, v26, v27
  v_mfma_f32_16x16x32_bf16 v[108:111], v[84:87], v[156:159], v[108:111]
  ds_read_b64_tr_b16 v[84:85], v6 offset:9728
  ds_read_b64_tr_b16 v[86:87], v6 offset:13824
  v_add_f32 v13, v13, v27
  v_exp_f32 v30, v106
  v_exp_f32 v31, v107
  v_add_f32 v13, v13, v28
  v_cvt_pk_bf16_f32 v50, v28, v29
  v_add_f32 v13, v13, v29
  v_add_f32 v13, v13, v30
  v_cvt_pk_bf16_f32 v51, v30, v31
  v_add_f32 v13, v13, v31
  v_cmp_lt_f32 vcc, s72, v13
  s_cbranch_vccz Lok_42
  s_swappc_b64 s[76:77], s[80:81]
Lok_42:
  v_add_f32 v10, v10, v13
  v_exp_f32 v24, v96
  v_exp_f32 v25, v97
  v_exp_f32 v26, v98
  v_exp_f32 v27, v99
  v_add_f32 v14, v24, v25
  v_cvt_pk_bf16_f32 v52, v24, v25
  v_add_f32 v14, v14, v26
  v_exp_f32 v28, v108
  v_exp_f32 v29, v109
  v_cvt_pk_bf16_f32 v53, v26, v27
  v_add_f32 v14, v14, v27
  v_exp_f32 v30, v110
  v_exp_f32 v31, v111
  v_add_f32 v14, v14, v28
  v_cvt_pk_bf16_f32 v54, v28, v29
  v_add_f32 v14, v14, v29
  v_add_f32 v14, v14, v30
  v_cvt_pk_bf16_f32 v55, v30, v31
  v_add_f32 v14, v14, v31
  v_cmp_lt_f32 vcc, s72, v14
  s_cbranch_vccz Lok_43
  s_swappc_b64 s[76:77], s[82:83]
Lok_43:
  v_add_f32 v11, v11, v14
  s_waitcnt vmcnt(5)
  s_waitcnt lgkmcnt(0)
  s_barrier
  s_setprio 0
  s_setprio 3
  v_mfma_f32_16x16x32_bf16 v[160:163], v[56:59], v[44:47], v[160:163]
  s_bfe_u32 s68, s56, 0x10001
  s_lshl_b32 s68, s68, 14
  s_add_u32 s68, s68, 65536
  v_subrev_u32 v5, s68, v5
  s_and_b32 s68, s56, 1
  s_lshl_b32 s68, s68, 5
  v_xor_b32 v5, s68, v5
  s_lshr_b32 s68, s56, 1
  s_lshl_b32 s68, s68, 9
  v_add_u32 v5, s68, v5
  v_add_u32 v6, 98304, v5
  ds_read_b64_tr_b16 v[112:113], v5 offset:0
  ds_read_b64_tr_b16 v[114:115], v5 offset:4096
  v_mfma_f32_16x16x32_bf16 v[164:167], v[56:59], v[48:51], v[164:167]
  ds_read_b64_tr_b16 v[116:117], v5 offset:8192
  ds_read_b64_tr_b16 v[118:119], v5 offset:12288
  ds_read_b64_tr_b16 v[120:121], v5 offset:16384
  v_mfma_f32_16x16x32_bf16 v[168:171], v[56:59], v[52:55], v[168:171]
  ds_read_b64_tr_b16 v[122:123], v5 offset:20480
  ds_read_b64_tr_b16 v[124:125], v5 offset:24576
  v_mfma_f32_16x16x32_bf16 v[172:175], v[60:63], v[44:47], v[172:175]
  ds_read_b64_tr_b16 v[126:127], v5 offset:28672
  ds_read_b64_tr_b16 v[128:129], v5 offset:32768
  ds_read_b64_tr_b16 v[130:131], v5 offset:36864
  v_mfma_f32_16x16x32_bf16 v[176:179], v[60:63], v[48:51], v[176:179]
  ds_read_b64_tr_b16 v[132:133], v5 offset:40960
  ds_read_b64_tr_b16 v[134:135], v5 offset:45056
  ds_read_b64_tr_b16 v[136:137], v5 offset:49152
  v_mfma_f32_16x16x32_bf16 v[180:183], v[60:63], v[52:55], v[180:183]
  ds_read_b64_tr_b16 v[138:139], v5 offset:53248
  ds_read_b64_tr_b16 v[140:141], v5 offset:57344
  v_mfma_f32_16x16x32_bf16 v[184:187], v[64:67], v[44:47], v[184:187]
  ds_read_b64_tr_b16 v[142:143], v5 offset:61440
  ds_read_b64_tr_b16 v[144:145], v6 offset:32768
  ds_read_b64_tr_b16 v[146:147], v6 offset:36864
  v_mfma_f32_16x16x32_bf16 v[188:191], v[64:67], v[48:51], v[188:191]
  ds_read_b64_tr_b16 v[148:149], v6 offset:40960
  ds_read_b64_tr_b16 v[150:151], v6 offset:45056
  ds_read_b64_tr_b16 v[152:153], v6 offset:49152
  v_mfma_f32_16x16x32_bf16 v[192:195], v[64:67], v[52:55], v[192:195]
  ds_read_b64_tr_b16 v[154:155], v6 offset:53248
  ds_read_b64_tr_b16 v[156:157], v6 offset:57344
  v_mfma_f32_16x16x32_bf16 v[196:199], v[68:71], v[44:47], v[196:199]
  ds_read_b64_tr_b16 v[158:159], v6 offset:61440
  v_mov_b32 v30, v9
  v_mov_b32 v31, v9
  s_nop 1
  v_permlane16_swap_b32 v30, v31
  s_nop 1
  v_add_f32 v30, v30, v31
  v_mov_b32 v31, v30
  s_nop 1
  v_permlane32_swap_b32 v30, v31
  s_nop 1
  v_add_f32 v9, v30, v31
  v_mov_b32 v30, v10
  v_mov_b32 v31, v10
  s_nop 1
  v_permlane16_swap_b32 v30, v31
  s_nop 1
  v_add_f32 v30, v30, v31
  v_mov_b32 v31, v30
  s_nop 1
  v_permlane32_swap_b32 v30, v31
  s_nop 1
  v_add_f32 v10, v30, v31
  v_mfma_f32_16x16x32_bf16 v[200:203], v[68:71], v[48:51], v[200:203]
  v_mov_b32 v30, v11
  v_mov_b32 v31, v11
  s_nop 1
  v_permlane16_swap_b32 v30, v31
  s_nop 1
  v_add_f32 v30, v30, v31
  v_mov_b32 v31, v30
  s_nop 1
  v_permlane32_swap_b32 v30, v31
  s_nop 1
  v_add_f32 v11, v30, v31
  s_mul_i32 s66, s56, 1536
  s_add_u32 s66, s66, 65536
  v_lshlrev_b32 v27, 2, v1
  v_add_u32 v26, s66, v27
  ds_write_b32 v26, v32 offset:0
  ds_write_b32 v26, v9 offset:768
  v_mfma_f32_16x16x32_bf16 v[204:207], v[68:71], v[52:55], v[204:207]
  ds_write_b32 v26, v36 offset:256
  ds_write_b32 v26, v10 offset:1024
  ds_write_b32 v26, v40 offset:512
  ds_write_b32 v26, v11 offset:1280
  s_waitcnt lgkmcnt(0)
  s_barrier
  s_and_b32 s66, s56, 1
  s_mul_i32 s66, s66, 1536
  s_add_u32 s66, s66, 65536
  v_add_u32 v26, s66, v27
  ds_read_b32 v88, v26 offset:0
  ds_read_b32 v89, v26 offset:256
  ds_read_b32 v90, v26 offset:512
  ds_read_b32 v91, v26 offset:768
  ds_read_b32 v92, v26 offset:1024
  ds_read_b32 v93, v26 offset:1280
  ds_read_b32 v94, v26 offset:3072
  ds_read_b32 v95, v26 offset:3328
  ds_read_b32 v96, v26 offset:3584
  ds_read_b32 v97, v26 offset:3840
  ds_read_b32 v98, v26 offset:4096
  ds_read_b32 v99, v26 offset:4352
  ds_read_b32 v100, v26 offset:6144
  ds_read_b32 v101, v26 offset:6400
  ds_read_b32 v102, v26 offset:6656
  ds_read_b32 v103, v26 offset:6912
  ds_read_b32 v104, v26 offset:7168
  ds_read_b32 v105, v26 offset:7424
  ds_read_b32 v106, v26 offset:9216
  ds_read_b32 v107, v26 offset:9472
  ds_read_b32 v108, v26 offset:9728
  ds_read_b32 v109, v26 offset:9984
  ds_read_b32 v110, v26 offset:10240
  ds_read_b32 v111, v26 offset:10496
  v_mfma_f32_16x16x32_bf16 v[208:211], v[72:75], v[44:47], v[208:211]
  v_mfma_f32_16x16x32_bf16 v[212:215], v[72:75], v[48:51], v[212:215]
  v_mfma_f32_16x16x32_bf16 v[216:219], v[72:75], v[52:55], v[216:219]
  v_mfma_f32_16x16x32_bf16 v[220:223], v[76:79], v[44:47], v[220:223]
  v_mfma_f32_16x16x32_bf16 v[224:227], v[76:79], v[48:51], v[224:227]
  v_mfma_f32_16x16x32_bf16 v[228:231], v[76:79], v[52:55], v[228:231]
  v_mfma_f32_16x16x32_bf16 v[232:235], v[80:83], v[44:47], v[232:235]
  v_mfma_f32_16x16x32_bf16 v[236:239], v[80:83], v[48:51], v[236:239]
  v_mfma_f32_16x16x32_bf16 v[240:243], v[80:83], v[52:55], v[240:243]
  v_mfma_f32_16x16x32_bf16 v[244:247], v[84:87], v[44:47], v[244:247]
  v_mfma_f32_16x16x32_bf16 v[248:251], v[84:87], v[48:51], v[248:251]
  v_mfma_f32_16x16x32_bf16 v[252:255], v[84:87], v[52:55], v[252:255]
  s_mov_b32 s66, 143360
  s_cmp_eq_u32 s57, 1
  s_cselect_b32 s66, 81920, s66
  s_cmp_eq_u32 s57, 2
  s_cselect_b32 s66, 49152, s66
  s_cmp_eq_u32 s57, 3
  s_cselect_b32 s66, 131072, s66
  s_add_u32 s66, s66, 0
  v_add_u32 v7, s66, v0
  s_mov_b32 s66, 0
  s_cmp_eq_u32 s57, 1
  s_cselect_b32 s66, 12288, s66
  s_cmp_eq_u32 s57, 2
  s_cselect_b32 s66, 24576, s66
  s_cmp_eq_u32 s57, 3
  s_cselect_b32 s66, 36864, s66
  s_add_u32 s66, s66, 3072
  v_add_u32 v8, s66, v0
  s_mov_b32 s66, 24576
  s_cmp_eq_u32 s57, 1
  s_cselect_b32 s66, 36864, s66
  s_cmp_eq_u32 s57, 2
  s_cselect_b32 s66, 0, s66
  s_cmp_eq_u32 s57, 3
  s_cselect_b32 s66, 12288, s66
  s_add_u32 s66, s66, 6144
  v_add_u32 v12, s66, v0
  s_mov_b32 s66, 49152
  s_cmp_eq_u32 s57, 1
  s_cselect_b32 s66, 131072, s66
  s_cmp_eq_u32 s57, 2
  s_cselect_b32 s66, 143360, s66
  s_cmp_eq_u32 s57, 3
  s_cselect_b32 s66, 81920, s66
  v_add_u32 v4, s66, v0
  s_waitcnt lgkmcnt(0)
  v_min3_f32 v24, v88, v94, v100
  v_min_f32 v24, v24, v106
  v_sub_f32 v88, v24, v88
  v_sub_f32 v94, v24, v94
  v_sub_f32 v100, v24, v100
  v_sub_f32 v106, v24, v106
  v_sub_f32 v44, v24, v32
  v_exp_f32 v88, v88
  v_exp_f32 v94, v94
  v_exp_f32 v100, v100
  v_exp_f32 v106, v106
  v_exp_f32 v44, v44
  v_mul_f32 v52, v88, v91
  v_fmac_f32 v52, v94, v97
  v_fmac_f32 v52, v100, v103
  v_fmac_f32 v52, v106, v109
  v_rcp_f32 v25, v52
  v_log_f32 v52, v52
  s_nop 0
  v_mul_f32 v44, v44, v25
  v_sub_f32 v52, v52, v24
  v_min3_f32 v24, v89, v95, v101
  v_min_f32 v24, v24, v107
  v_sub_f32 v89, v24, v89
  v_sub_f32 v95, v24, v95
  v_sub_f32 v101, v24, v101
  v_sub_f32 v107, v24, v107
  v_sub_f32 v46, v24, v36
  v_exp_f32 v89, v89
  v_exp_f32 v95, v95
  v_exp_f32 v101, v101
  v_exp_f32 v107, v107
  v_exp_f32 v46, v46
  v_mul_f32 v53, v89, v92
  v_fmac_f32 v53, v95, v98
  v_fmac_f32 v53, v101, v104
  v_fmac_f32 v53, v107, v110
  v_rcp_f32 v25, v53
  v_log_f32 v53, v53
  s_nop 0
  v_mul_f32 v46, v46, v25
  v_sub_f32 v53, v53, v24
  v_min3_f32 v24, v90, v96, v102
  v_min_f32 v24, v24, v108
  v_sub_f32 v90, v24, v90
  v_sub_f32 v96, v24, v96
  v_sub_f32 v102, v24, v102
  v_sub_f32 v108, v24, v108
  v_sub_f32 v48, v24, v40
  v_exp_f32 v90, v90
  v_exp_f32 v96, v96
  v_exp_f32 v102, v102
  v_exp_f32 v108, v108
  v_exp_f32 v48, v48
  v_mul_f32 v54, v90, v93
  v_fmac_f32 v54, v96, v99
  v_fmac_f32 v54, v102, v105
  v_fmac_f32 v54, v108, v111
  v_rcp_f32 v25, v54
  v_log_f32 v54, v54
  s_nop 0
  v_mul_f32 v48, v48, v25
  v_sub_f32 v54, v54, v24
  s_mov_b32 s69, 0xffff0000
  s_bitcmp1_b32 s56, 1
  s_cbranch_scc1 Lc_44
  v_pk_mul_f32 v[160:161], v[160:161], v[44:45] op_sel_hi:[1,0]
  v_pk_mul_f32 v[162:163], v[162:163], v[44:45] op_sel_hi:[1,0]
  v_cvt_pk_bf16_f32 v68, v160, v161
  v_cvt_pk_bf16_f32 v69, v162, v163
  v_pk_mul_f32 v[172:173], v[172:173], v[44:45] op_sel_hi:[1,0]
  v_pk_mul_f32 v[174:175], v[174:175], v[44:45] op_sel_hi:[1,0]
  v_cvt_pk_bf16_f32 v70, v172, v173
  v_cvt_pk_bf16_f32 v71, v174, v175
  ds_write_b128 v8, v[68:71] offset:0
  v_pk_mul_f32 v[164:165], v[164:165], v[46:47] op_sel_hi:[1,0]
  v_pk_mul_f32 v[166:167], v[166:167], v[46:47] op_sel_hi:[1,0]
  v_cvt_pk_bf16_f32 v72, v164, v165
  v_cvt_pk_bf16_f32 v73, v166, v167
  v_pk_mul_f32 v[176:177], v[176:177], v[46:47] op_sel_hi:[1,0]
  v_pk_mul_f32 v[178:179], v[178:179], v[46:47] op_sel_hi:[1,0]
  v_cvt_pk_bf16_f32 v74, v176, v177
  v_cvt_pk_bf16_f32 v75, v178, v179
  ds_write_b128 v8, v[72:75] offset:1024
  v_pk_mul_f32 v[168:169], v[168:169], v[48:49] op_sel_hi:[1,0]
  v_pk_mul_f32 v[170:171], v[170:171], v[48:49] op_sel_hi:[1,0]
  v_cvt_pk_bf16_f32 v76, v168, v169
  v_cvt_pk_bf16_f32 v77, v170, v171
  v_pk_mul_f32 v[180:181], v[180:181], v[48:49] op_sel_hi:[1,0]
  v_pk_mul_f32 v[182:183], v[182:183], v[48:49] op_sel_hi:[1,0]
  v_cvt_pk_bf16_f32 v78, v180, v181
  v_cvt_pk_bf16_f32 v79, v182, v183
  ds_write_b128 v8, v[76:79] offset:2048
  v_pk_mul_f32 v[184:185], v[184:185], v[44:45] op_sel_hi:[1,0]
  v_pk_mul_f32 v[186:187], v[186:187], v[44:45] op_sel_hi:[1,0]
  v_cvt_pk_bf16_f32 v80, v184, v185
  v_cvt_pk_bf16_f32 v81, v186, v187
  v_pk_mul_f32 v[196:197], v[196:197], v[44:45] op_sel_hi:[1,0]
  v_pk_mul_f32 v[198:199], v[198:199], v[44:45] op_sel_hi:[1,0]
  v_cvt_pk_bf16_f32 v82, v196, v197
  v_cvt_pk_bf16_f32 v83, v198, v199
  ds_write_b128 v12, v[80:83] offset:0
  v_pk_mul_f32 v[188:189], v[188:189], v[46:47] op_sel_hi:[1,0]
  v_pk_mul_f32 v[190:191], v[190:191], v[46:47] op_sel_hi:[1,0]
  v_cvt_pk_bf16_f32 v68, v188, v189
  v_cvt_pk_bf16_f32 v69, v190, v191
  v_pk_mul_f32 v[200:201], v[200:201], v[46:47] op_sel_hi:[1,0]
  v_pk_mul_f32 v[202:203], v[202:203], v[46:47] op_sel_hi:[1,0]
  v_cvt_pk_bf16_f32 v70, v200, v201
  v_cvt_pk_bf16_f32 v71, v202, v203
  ds_write_b128 v12, v[68:71] offset:1024
  v_pk_mul_f32 v[192:193], v[192:193], v[48:49] op_sel_hi:[1,0]
  v_pk_mul_f32 v[194:195], v[194:195], v[48:49] op_sel_hi:[1,0]
  v_cvt_pk_bf16_f32 v72, v192, v193
  v_cvt_pk_bf16_f32 v73, v194, v195
  v_pk_mul_f32 v[204:205], v[204:205], v[48:49] op_sel_hi:[1,0]
  v_pk_mul_f32 v[206:207], v[206:207], v[48:49] op_sel_hi:[1,0]
  v_cvt_pk_bf16_f32 v74, v204, v205
  v_cvt_pk_bf16_f32 v75, v206, v207
  ds_write_b128 v12, v[72:75] offset:2048
  v_pk_mul_f32 v[232:233], v[232:233], v[44:45] op_sel_hi:[1,0]
  v_pk_mul_f32 v[234:235], v[234:235], v[44:45] op_sel_hi:[1,0]
  v_cvt_pk_bf16_f32 v76, v232, v233
  v_cvt_pk_bf16_f32 v77, v234, v235
  v_pk_mul_f32 v[244:245], v[244:245], v[44:45] op_sel_hi:[1,0]
  v_pk_mul_f32 v[246:247], v[246:247], v[44:45] op_sel_hi:[1,0]
  v_cvt_pk_bf16_f32 v78, v244, v245
  v_cvt_pk_bf16_f32 v79, v246, v247
  ds_write_b128 v7, v[76:79] offset:0
  v_pk_mul_f32 v[236:237], v[236:237], v[46:47] op_sel_hi:[1,0]
  v_pk_mul_f32 v[238:239], v[238:239], v[46:47] op_sel_hi:[1,0]
  v_cvt_pk_bf16_f32 v80, v236, v237
  v_cvt_pk_bf16_f32 v81, v238, v239
  v_pk_mul_f32 v[248:249], v[248:249], v[46:47] op_sel_hi:[1,0]
  v_pk_mul_f32 v[250:251], v[250:251], v[46:47] op_sel_hi:[1,0]
  v_cvt_pk_bf16_f32 v82, v248, v249
  v_cvt_pk_bf16_f32 v83, v250, v251
  ds_write_b128 v7, v[80:83] offset:1024
  v_pk_mul_f32 v[240:241], v[240:241], v[48:49] op_sel_hi:[1,0]
  v_pk_mul_f32 v[242:243], v[242:243], v[48:49] op_sel_hi:[1,0]
  v_cvt_pk_bf16_f32 v68, v240, v241
  v_cvt_pk_bf16_f32 v69, v242, v243
  v_pk_mul_f32 v[252:253], v[252:253], v[48:49] op_sel_hi:[1,0]
  v_pk_mul_f32 v[254:255], v[254:255], v[48:49] op_sel_hi:[1,0]
  v_cvt_pk_bf16_f32 v70, v252, v253
  v_cvt_pk_bf16_f32 v71, v254, v255
  ds_write_b128 v7, v[68:71] offset:2048
  v_pk_mul_f32 v[208:209], v[208:209], v[44:45] op_sel_hi:[1,0]
  v_pk_mul_f32 v[210:211], v[210:211], v[44:45] op_sel_hi:[1,0]
  v_pk_mul_f32 v[220:221], v[220:221], v[44:45] op_sel_hi:[1,0]
  v_pk_mul_f32 v[222:223], v[222:223], v[44:45] op_sel_hi:[1,0]
  v_pk_mul_f32 v[212:213], v[212:213], v[46:47] op_sel_hi:[1,0]
  v_pk_mul_f32 v[214:215], v[214:215], v[46:47] op_sel_hi:[1,0]
  v_pk_mul_f32 v[224:225], v[224:225], v[46:47] op_sel_hi:[1,0]
  v_pk_mul_f32 v[226:227], v[226:227], v[46:47] op_sel_hi:[1,0]
  v_pk_mul_f32 v[216:217], v[216:217], v[48:49] op_sel_hi:[1,0]
  v_pk_mul_f32 v[218:219], v[218:219], v[48:49] op_sel_hi:[1,0]
  v_pk_mul_f32 v[228:229], v[228:229], v[48:49] op_sel_hi:[1,0]
  v_pk_mul_f32 v[230:231], v[230:231], v[48:49] op_sel_hi:[1,0]
  s_waitcnt lgkmcnt(0)
  s_barrier
  s_setprio 0
  ds_read_b128 v[88:91], v4 offset:0
  ds_read_b128 v[92:95], v4 offset:1024
  ds_read_b128 v[96:99], v4 offset:2048
  ds_read_b128 v[100:103], v4 offset:3072
  ds_read_b128 v[104:107], v4 offset:4096
  ds_read_b128 v[108:111], v4 offset:5120
  ds_read_b128 v[32:35], v4 offset:6144
  ds_read_b128 v[36:39], v4 offset:7168
  ds_read_b128 v[40:43], v4 offset:8192
  s_waitcnt lgkmcnt(6)
  v_lshlrev_b32 v24, 16, v88
  v_and_b32 v25, s69, v88
  v_pk_add_f32 v[208:209], v[208:209], v[24:25]
  v_lshlrev_b32 v26, 16, v89
  v_and_b32 v27, s69, v89
  v_pk_add_f32 v[210:211], v[210:211], v[26:27]
  v_lshlrev_b32 v24, 16, v90
  v_and_b32 v25, s69, v90
  v_pk_add_f32 v[220:221], v[220:221], v[24:25]
  v_lshlrev_b32 v26, 16, v91
  v_and_b32 v27, s69, v91
  v_pk_add_f32 v[222:223], v[222:223], v[26:27]
  v_lshlrev_b32 v24, 16, v92
  v_and_b32 v25, s69, v92
  v_pk_add_f32 v[212:213], v[212:213], v[24:25]
  v_lshlrev_b32 v26, 16, v93
  v_and_b32 v27, s69, v93
  v_pk_add_f32 v[214:215], v[214:215], v[26:27]
  v_lshlrev_b32 v24, 16, v94
  v_and_b32 v25, s69, v94
  v_pk_add_f32 v[224:225], v[224:225], v[24:25]
  v_lshlrev_b32 v26, 16, v95
  v_and_b32 v27, s69, v95
  v_pk_add_f32 v[226:227], v[226:227], v[26:27]
  v_lshlrev_b32 v24, 16, v96
  v_and_b32 v25, s69, v96
  v_pk_add_f32 v[216:217], v[216:217], v[24:25]
  v_lshlrev_b32 v26, 16, v97
  v_and_b32 v27, s69, v97
  v_pk_add_f32 v[218:219], v[218:219], v[26:27]
  v_lshlrev_b32 v24, 16, v98
  v_and_b32 v25, s69, v98
  v_pk_add_f32 v[228:229], v[228:229], v[24:25]
  v_lshlrev_b32 v26, 16, v99
  v_and_b32 v27, s69, v99
  v_pk_add_f32 v[230:231], v[230:231], v[26:27]
  s_waitcnt lgkmcnt(3)
  v_lshlrev_b32 v24, 16, v100
  v_and_b32 v25, s69, v100
  v_pk_add_f32 v[208:209], v[208:209], v[24:25]
  v_lshlrev_b32 v26, 16, v101
  v_and_b32 v27, s69, v101
  v_pk_add_f32 v[210:211], v[210:211], v[26:27]
  v_lshlrev_b32 v24, 16, v102
  v_and_b32 v25, s69, v102
  v_pk_add_f32 v[220:221], v[220:221], v[24:25]
  v_lshlrev_b32 v26, 16, v103
  v_and_b32 v27, s69, v103
  v_pk_add_f32 v[222:223], v[222:223], v[26:27]
  v_lshlrev_b32 v24, 16, v104
  v_and_b32 v25, s69, v104
  v_pk_add_f32 v[212:213], v[212:213], v[24:25]
  v_lshlrev_b32 v26, 16, v105
  v_and_b32 v27, s69, v105
  v_pk_add_f32 v[214:215], v[214:215], v[26:27]
  v_lshlrev_b32 v24, 16, v106
  v_and_b32 v25, s69, v106
  v_pk_add_f32 v[224:225], v[224:225], v[24:25]
  v_lshlrev_b32 v26, 16, v107
  v_and_b32 v27, s69, v107
  v_pk_add_f32 v[226:227], v[226:227], v[26:27]
  v_lshlrev_b32 v24, 16, v108
  v_and_b32 v25, s69, v108
  v_pk_add_f32 v[216:217], v[216:217], v[24:25]
  v_lshlrev_b32 v26, 16, v109
  v_and_b32 v27, s69, v109
  v_pk_add_f32 v[218:219], v[218:219], v[26:27]
  v_lshlrev_b32 v24, 16, v110
  v_and_b32 v25, s69, v110
  v_pk_add_f32 v[228:229], v[228:229], v[24:25]
  v_lshlrev_b32 v26, 16, v111
  v_and_b32 v27, s69, v111
  v_pk_add_f32 v[230:231], v[230:231], v[26:27]
  s_waitcnt lgkmcnt(0)
  v_lshlrev_b32 v24, 16, v32
  v_and_b32 v25, s69, v32
  v_pk_add_f32 v[208:209], v[208:209], v[24:25]
  v_lshlrev_b32 v26, 16, v33
  v_and_b32 v27, s69, v33
  v_pk_add_f32 v[210:211], v[210:211], v[26:27]
  v_lshlrev_b32 v24, 16, v34
  v_and_b32 v25, s69, v34
  v_pk_add_f32 v[220:221], v[220:221], v[24:25]
  v_lshlrev_b32 v26, 16, v35
  v_and_b32 v27, s69, v35
  v_pk_add_f32 v[222:223], v[222:223], v[26:27]
  v_lshlrev_b32 v24, 16, v36
  v_and_b32 v25, s69, v36
  v_pk_add_f32 v[212:213], v[212:213], v[24:25]
  v_lshlrev_b32 v26, 16, v37
  v_and_b32 v27, s69, v37
  v_pk_add_f32 v[214:215], v[214:215], v[26:27]
  v_lshlrev_b32 v24, 16, v38
  v_and_b32 v25, s69, v38
  v_pk_add_f32 v[224:225], v[224:225], v[24:25]
  v_lshlrev_b32 v26, 16, v39
  v_and_b32 v27, s69, v39
  v_pk_add_f32 v[226:227], v[226:227], v[26:27]
  v_lshlrev_b32 v24, 16, v40
  v_and_b32 v25, s69, v40
  v_pk_add_f32 v[216:217], v[216:217], v[24:25]
  v_lshlrev_b32 v26, 16, v41
  v_and_b32 v27, s69, v41
  v_pk_add_f32 v[218:219], v[218:219], v[26:27]
  v_lshlrev_b32 v24, 16, v42
  v_and_b32 v25, s69, v42
  v_pk_add_f32 v[228:229], v[228:229], v[24:25]
  v_lshlrev_b32 v26, 16, v43
  v_and_b32 v27, s69, v43
  v_pk_add_f32 v[230:231], v[230:231], v[26:27]
  v_cvt_pk_bf16_f32 v56, v208, v209
  v_cvt_pk_bf16_f32 v57, v210, v211
  v_cvt_pk_bf16_f32 v58, v220, v221
  v_cvt_pk_bf16_f32 v59, v222, v223
  v_cvt_pk_bf16_f32 v60, v212, v213
  v_cvt_pk_bf16_f32 v61, v214, v215
  v_cvt_pk_bf16_f32 v62, v224, v225
  v_cvt_pk_bf16_f32 v63, v226, v227
  v_cvt_pk_bf16_f32 v64, v216, v217
  v_cvt_pk_bf16_f32 v65, v218, v219
  v_cvt_pk_bf16_f32 v66, v228, v229
  v_cvt_pk_bf16_f32 v67, v230, v231
  s_branch L_tail
Lc_44:
  v_pk_mul_f32 v[160:161], v[160:161], v[44:45] op_sel_hi:[1,0]
  v_pk_mul_f32 v[162:163], v[162:163], v[44:45] op_sel_hi:[1,0]
  v_cvt_pk_bf16_f32 v68, v160, v161
  v_cvt_pk_bf16_f32 v69, v162, v163
  v_pk_mul_f32 v[172:173], v[172:173], v[44:45] op_sel_hi:[1,0]
  v_pk_mul_f32 v[174:175], v[174:175], v[44:45] op_sel_hi:[1,0]
  v_cvt_pk_bf16_f32 v70, v172, v173
  v_cvt_pk_bf16_f32 v71, v174, v175
  ds_write_b128 v12, v[68:71] offset:0
  v_pk_mul_f32 v[164:165], v[164:165], v[46:47] op_sel_hi:[1,0]
  v_pk_mul_f32 v[166:167], v[166:167], v[46:47] op_sel_hi:[1,0]
  v_cvt_pk_bf16_f32 v72, v164, v165
  v_cvt_pk_bf16_f32 v73, v166, v167
  v_pk_mul_f32 v[176:177], v[176:177], v[46:47] op_sel_hi:[1,0]
  v_pk_mul_f32 v[178:179], v[178:179], v[46:47] op_sel_hi:[1,0]
  v_cvt_pk_bf16_f32 v74, v176, v177
  v_cvt_pk_bf16_f32 v75, v178, v179
  ds_write_b128 v12, v[72:75] offset:1024
  v_pk_mul_f32 v[168:169], v[168:169], v[48:49] op_sel_hi:[1,0]
  v_pk_mul_f32 v[170:171], v[170:171], v[48:49] op_sel_hi:[1,0]
  v_cvt_pk_bf16_f32 v76, v168, v169
  v_cvt_pk_bf16_f32 v77, v170, v171
  v_pk_mul_f32 v[180:181], v[180:181], v[48:49] op_sel_hi:[1,0]
  v_pk_mul_f32 v[182:183], v[182:183], v[48:49] op_sel_hi:[1,0]
  v_cvt_pk_bf16_f32 v78, v180, v181
  v_cvt_pk_bf16_f32 v79, v182, v183
  ds_write_b128 v12, v[76:79] offset:2048
  v_pk_mul_f32 v[184:185], v[184:185], v[44:45] op_sel_hi:[1,0]
  v_pk_mul_f32 v[186:187], v[186:187], v[44:45] op_sel_hi:[1,0]
  v_cvt_pk_bf16_f32 v80, v184, v185
  v_cvt_pk_bf16_f32 v81, v186, v187
  v_pk_mul_f32 v[196:197], v[196:197], v[44:45] op_sel_hi:[1,0]
  v_pk_mul_f32 v[198:199], v[198:199], v[44:45] op_sel_hi:[1,0]
  v_cvt_pk_bf16_f32 v82, v196, v197
  v_cvt_pk_bf16_f32 v83, v198, v199
  ds_write_b128 v8, v[80:83] offset:0
  v_pk_mul_f32 v[188:189], v[188:189], v[46:47] op_sel_hi:[1,0]
  v_pk_mul_f32 v[190:191], v[190:191], v[46:47] op_sel_hi:[1,0]
  v_cvt_pk_bf16_f32 v68, v188, v189
  v_cvt_pk_bf16_f32 v69, v190, v191
  v_pk_mul_f32 v[200:201], v[200:201], v[46:47] op_sel_hi:[1,0]
  v_pk_mul_f32 v[202:203], v[202:203], v[46:47] op_sel_hi:[1,0]
  v_cvt_pk_bf16_f32 v70, v200, v201
  v_cvt_pk_bf16_f32 v71, v202, v203
  ds_write_b128 v8, v[68:71] offset:1024
  v_pk_mul_f32 v[192:193], v[192:193], v[48:49] op_sel_hi:[1,0]
  v_pk_mul_f32 v[194:195], v[194:195], v[48:49] op_sel_hi:[1,0]
  v_cvt_pk_bf16_f32 v72, v192, v193
  v_cvt_pk_bf16_f32 v73, v194, v195
  v_pk_mul_f32 v[204:205], v[204:205], v[48:49] op_sel_hi:[1,0]
  v_pk_mul_f32 v[206:207], v[206:207], v[48:49] op_sel_hi:[1,0]
  v_cvt_pk_bf16_f32 v74, v204, v205
  v_cvt_pk_bf16_f32 v75, v206, v207
  ds_write_b128 v8, v[72:75] offset:2048
  v_pk_mul_f32 v[208:209], v[208:209], v[44:45] op_sel_hi:[1,0]
  v_pk_mul_f32 v[210:211], v[210:211], v[44:45] op_sel_hi:[1,0]
  v_cvt_pk_bf16_f32 v76, v208, v209
  v_cvt_pk_bf16_f32 v77, v210, v211
  v_pk_mul_f32 v[220:221], v[220:221], v[44:45] op_sel_hi:[1,0]
  v_pk_mul_f32 v[222:223], v[222:223], v[44:45] op_sel_hi:[1,0]
  v_cvt_pk_bf16_f32 v78, v220, v221
  v_cvt_pk_bf16_f32 v79, v222, v223
  ds_write_b128 v7, v[76:79] offset:0
  v_pk_mul_f32 v[212:213], v[212:213], v[46:47] op_sel_hi:[1,0]
  v_pk_mul_f32 v[214:215], v[214:215], v[46:47] op_sel_hi:[1,0]
  v_cvt_pk_bf16_f32 v80, v212, v213
  v_cvt_pk_bf16_f32 v81, v214, v215
  v_pk_mul_f32 v[224:225], v[224:225], v[46:47] op_sel_hi:[1,0]
  v_pk_mul_f32 v[226:227], v[226:227], v[46:47] op_sel_hi:[1,0]
  v_cvt_pk_bf16_f32 v82, v224, v225
  v_cvt_pk_bf16_f32 v83, v226, v227
  ds_write_b128 v7, v[80:83] offset:1024
  v_pk_mul_f32 v[216:217], v[216:217], v[48:49] op_sel_hi:[1,0]
  v_pk_mul_f32 v[218:219], v[218:219], v[48:49] op_sel_hi:[1,0]
  v_cvt_pk_bf16_f32 v68, v216, v217
  v_cvt_pk_bf16_f32 v69, v218, v219
  v_pk_mul_f32 v[228:229], v[228:229], v[48:49] op_sel_hi:[1,0]
  v_pk_mul_f32 v[230:231], v[230:231], v[48:49] op_sel_hi:[1,0]
  v_cvt_pk_bf16_f32 v70, v228, v229
  v_cvt_pk_bf16_f32 v71, v230, v231
  ds_write_b128 v7, v[68:71] offset:2048
  v_pk_mul_f32 v[232:233], v[232:233], v[44:45] op_sel_hi:[1,0]
  v_pk_mul_f32 v[234:235], v[234:235], v[44:45] op_sel_hi:[1,0]
  v_pk_mul_f32 v[244:245], v[244:245], v[44:45] op_sel_hi:[1,0]
  v_pk_mul_f32 v[246:247], v[246:247], v[44:45] op_sel_hi:[1,0]
  v_pk_mul_f32 v[236:237], v[236:237], v[46:47] op_sel_hi:[1,0]
  v_pk_mul_f32 v[238:239], v[238:239], v[46:47] op_sel_hi:[1,0]
  v_pk_mul_f32 v[248:249], v[248:249], v[46:47] op_sel_hi:[1,0]
  v_pk_mul_f32 v[250:251], v[250:251], v[46:47] op_sel_hi:[1,0]
  v_pk_mul_f32 v[240:241], v[240:241], v[48:49] op_sel_hi:[1,0]
  v_pk_mul_f32 v[242:243], v[242:243], v[48:49] op_sel_hi:[1,0]
  v_pk_mul_f32 v[252:253], v[252:253], v[48:49] op_sel_hi:[1,0]
  v_pk_mul_f32 v[254:255], v[254:255], v[48:49] op_sel_hi:[1,0]
  s_waitcnt lgkmcnt(0)
  s_barrier
  s_setprio 0
  ds_read_b128 v[88:91], v4 offset:0
  ds_read_b128 v[92:95], v4 offset:1024
  ds_read_b128 v[96:99], v4 offset:2048
  ds_read_b128 v[100:103], v4 offset:3072
  ds_read_b128 v[104:107], v4 offset:4096
  ds_read_b128 v[108:111], v4 offset:5120
  ds_read_b128 v[32:35], v4 offset:6144
  ds_read_b128 v[36:39], v4 offset:7168
  ds_read_b128 v[40:43], v4 offset:8192
  s_waitcnt lgkmcnt(6)
  v_lshlrev_b32 v24, 16, v88
  v_and_b32 v25, s69, v88
  v_pk_add_f32 v[232:233], v[232:233], v[24:25]
  v_lshlrev_b32 v26, 16, v89
  v_and_b32 v27, s69, v89
  v_pk_add_f32 v[234:235], v[234:235], v[26:27]
  v_lshlrev_b32 v24, 16, v90
  v_and_b32 v25, s69, v90
  v_pk_add_f32 v[244:245], v[244:245], v[24:25]
  v_lshlrev_b32 v26, 16, v91
  v_and_b32 v27, s69, v91
  v_pk_add_f32 v[246:247], v[246:247], v[26:27]
  v_lshlrev_b32 v24, 16, v92
  v_and_b32 v25, s69, v92
  v_pk_add_f32 v[236:237], v[236:237], v[24:25]
  v_lshlrev_b32 v26, 16, v93
  v_and_b32 v27, s69, v93
  v_pk_add_f32 v[238:239], v[238:239], v[26:27]
  v_lshlrev_b32 v24, 16, v94
  v_and_b32 v25, s69, v94
  v_pk_add_f32 v[248:249], v[248:249], v[24:25]
  v_lshlrev_b32 v26, 16, v95
  v_and_b32 v27, s69, v95
  v_pk_add_f32 v[250:251], v[250:251], v[26:27]
  v_lshlrev_b32 v24, 16, v96
  v_and_b32 v25, s69, v96
  v_pk_add_f32 v[240:241], v[240:241], v[24:25]
  v_lshlrev_b32 v26, 16, v97
  v_and_b32 v27, s69, v97
  v_pk_add_f32 v[242:243], v[242:243], v[26:27]
  v_lshlrev_b32 v24, 16, v98
  v_and_b32 v25, s69, v98
  v_pk_add_f32 v[252:253], v[252:253], v[24:25]
  v_lshlrev_b32 v26, 16, v99
  v_and_b32 v27, s69, v99
  v_pk_add_f32 v[254:255], v[254:255], v[26:27]
  s_waitcnt lgkmcnt(3)
  v_lshlrev_b32 v24, 16, v100
  v_and_b32 v25, s69, v100
  v_pk_add_f32 v[232:233], v[232:233], v[24:25]
  v_lshlrev_b32 v26, 16, v101
  v_and_b32 v27, s69, v101
  v_pk_add_f32 v[234:235], v[234:235], v[26:27]
  v_lshlrev_b32 v24, 16, v102
  v_and_b32 v25, s69, v102
  v_pk_add_f32 v[244:245], v[244:245], v[24:25]
  v_lshlrev_b32 v26, 16, v103
  v_and_b32 v27, s69, v103
  v_pk_add_f32 v[246:247], v[246:247], v[26:27]
  v_lshlrev_b32 v24, 16, v104
  v_and_b32 v25, s69, v104
  v_pk_add_f32 v[236:237], v[236:237], v[24:25]
  v_lshlrev_b32 v26, 16, v105
  v_and_b32 v27, s69, v105
  v_pk_add_f32 v[238:239], v[238:239], v[26:27]
  v_lshlrev_b32 v24, 16, v106
  v_and_b32 v25, s69, v106
  v_pk_add_f32 v[248:249], v[248:249], v[24:25]
  v_lshlrev_b32 v26, 16, v107
  v_and_b32 v27, s69, v107
  v_pk_add_f32 v[250:251], v[250:251], v[26:27]
  v_lshlrev_b32 v24, 16, v108
  v_and_b32 v25, s69, v108
  v_pk_add_f32 v[240:241], v[240:241], v[24:25]
  v_lshlrev_b32 v26, 16, v109
  v_and_b32 v27, s69, v109
  v_pk_add_f32 v[242:243], v[242:243], v[26:27]
  v_lshlrev_b32 v24, 16, v110
  v_and_b32 v25, s69, v110
  v_pk_add_f32 v[252:253], v[252:253], v[24:25]
  v_lshlrev_b32 v26, 16, v111
  v_and_b32 v27, s69, v111
  v_pk_add_f32 v[254:255], v[254:255], v[26:27]
  s_waitcnt lgkmcnt(0)
  v_lshlrev_b32 v24, 16, v32
  v_and_b32 v25, s69, v32
  v_pk_add_f32 v[232:233], v[232:233], v[24:25]
  v_lshlrev_b32 v26, 16, v33
  v_and_b32 v27, s69, v33
  v_pk_add_f32 v[234:235], v[234:235], v[26:27]
  v_lshlrev_b32 v24, 16, v34
  v_and_b32 v25, s69, v34
  v_pk_add_f32 v[244:245], v[244:245], v[24:25]
  v_lshlrev_b32 v26, 16, v35
  v_and_b32 v27, s69, v35
  v_pk_add_f32 v[246:247], v[246:247], v[26:27]
  v_lshlrev_b32 v24, 16, v36
  v_and_b32 v25, s69, v36
  v_pk_add_f32 v[236:237], v[236:237], v[24:25]
  v_lshlrev_b32 v26, 16, v37
  v_and_b32 v27, s69, v37
  v_pk_add_f32 v[238:239], v[238:239], v[26:27]
  v_lshlrev_b32 v24, 16, v38
  v_and_b32 v25, s69, v38
  v_pk_add_f32 v[248:249], v[248:249], v[24:25]
  v_lshlrev_b32 v26, 16, v39
  v_and_b32 v27, s69, v39
  v_pk_add_f32 v[250:251], v[250:251], v[26:27]
  v_lshlrev_b32 v24, 16, v40
  v_and_b32 v25, s69, v40
  v_pk_add_f32 v[240:241], v[240:241], v[24:25]
  v_lshlrev_b32 v26, 16, v41
  v_and_b32 v27, s69, v41
  v_pk_add_f32 v[242:243], v[242:243], v[26:27]
  v_lshlrev_b32 v24, 16, v42
  v_and_b32 v25, s69, v42
  v_pk_add_f32 v[252:253], v[252:253], v[24:25]
  v_lshlrev_b32 v26, 16, v43
  v_and_b32 v27, s69, v43
  v_pk_add_f32 v[254:255], v[254:255], v[26:27]
  v_cvt_pk_bf16_f32 v56, v232, v233
  v_cvt_pk_bf16_f32 v57, v234, v235
  v_cvt_pk_bf16_f32 v58, v244, v245
  v_cvt_pk_bf16_f32 v59, v246, v247
  v_cvt_pk_bf16_f32 v60, v236, v237
  v_cvt_pk_bf16_f32 v61, v238, v239
  v_cvt_pk_bf16_f32 v62, v248, v249
  v_cvt_pk_bf16_f32 v63, v250, v251
  v_cvt_pk_bf16_f32 v64, v240, v241
  v_cvt_pk_bf16_f32 v65, v242, v243
  v_cvt_pk_bf16_f32 v66, v252, v253
  v_cvt_pk_bf16_f32 v67, v254, v255
L_tail:
  s_mov_b32 s86, 0
  s_lshl_b32 s68, s60, 3
  v_mov_b32 v28, s68
L_tag:
  s_waitcnt vmcnt(0)
  v_readfirstlane_b32 s64, v18
  v_readfirstlane_b32 s65, v19
  s_add_u32 s86, s86, 1
  s_cmp_lg_u32 s64, 0
  s_cbranch_scc1 L_tag_ok
  s_cmp_gt_u32 s86, 0x10000
  s_cbranch_scc1 L_tag_ok
  buffer_load_dwordx2 v[18:19], v28, s[28:31], 0 offen sc1
  s_branch L_tag
L_tag_ok:
  s_lshl_b32 s66, s2, 3
  s_add_u32 s66, s66, s56
  s_mul_i32 s67, s66, 3584
  v_mov_b32 v68, v18
  v_mov_b32 v69, v19
  v_mov_b32 v70, s98
  v_mov_b32 v71, 0
  s_xor_b32 s88, s66, 64
  s_mul_i32 s88, s88, 3584
  s_xor_b32 s89, s66, 128
  s_mul_i32 s89, s89, 3584
  s_xor_b32 s90, s66, 192
  s_mul_i32 s90, s90, 3584
  v_add_u32 v15, 1, v2
  v_lshlrev_b32 v15, 6, v15
  v_xor_b32 v15, s66, v15
  v_mul_u32_u24 v15, 3584, v15
  v_lshlrev_b32 v16, 24, v3
  v_add_u32 v15, v15, v16
  buffer_store_dwordx4 v[56:59], v0, s[32:35], s67 offen offset:0
  buffer_store_dwordx4 v[60:63], v0, s[32:35], s67 offen offset:1024
  buffer_store_dwordx4 v[64:67], v0, s[32:35], s67 offen offset:2048
  s_mov_b64 exec, 0xffff
  buffer_store_dwordx4 v[52:55], v0, s[32:35], s67 offen offset:3072
  s_mov_b64 exec, 1
  s_waitcnt vmcnt(0)
  buffer_store_dwordx4 v[68:71], v0, s[32:35], s67 offen offset:3328
  s_mov_b64 exec, -1
  s_mov_b32 s86, 0
  s_mov_b64 exec, 7
L_f1:
  buffer_load_dwordx4 v[28:31], v15, s[32:35], 0 offen offset:3328 nt
  s_add_u32 s86, s86, 1
  s_waitcnt vmcnt(0)
  v_cmp_eq_u64 vcc, s[64:65], v[28:29]
  v_cmp_eq_u32 s[84:85], s98, v30
  s_andn2_b32 s85, vcc_lo, s84
  s_cbranch_scc1 L_fremote
  s_cmp_eq_u32 vcc_lo, 7
  s_cbranch_scc1 L_flocal
  s_cmp_lt_u32 s86, 12
  s_cbranch_scc1 L_f1
L_fremote:
  s_mov_b64 exec, -1
  s_add_u32 s67, s67, 0x1000000
  buffer_store_dwordx4 v[56:59], v0, s[32:35], s67 offen offset:0 sc1
  buffer_store_dwordx4 v[60:63], v0, s[32:35], s67 offen offset:1024 sc1
  buffer_store_dwordx4 v[64:67], v0, s[32:35], s67 offen offset:2048 sc1
  s_mov_b64 exec, 0xffff
  buffer_store_dwordx4 v[52:55], v0, s[32:35], s67 offen offset:3072 sc1
  s_mov_b64 exec, 1
  s_waitcnt vmcnt(0)
  buffer_store_dwordx4 v[68:71], v0, s[32:35], s67 offen offset:3328 sc1
  s_mov_b64 exec, -1
  s_mov_b64 exec, 0x70007
L_f2:
  buffer_load_dwordx4 v[28:31], v15, s[32:35], 0 offen offset:3328 sc1
  s_add_u32 s86, s86, 1
  s_waitcnt vmcnt(0)
  v_cmp_eq_u64 vcc, s[64:65], v[28:29]
  v_cmp_eq_u32 s[84:85], s98, v30
  s_and_b32 s84, s84, vcc_lo
  s_and_b32 s84, s84, 7
  s_cmp_eq_u32 s84, 7
  s_cbranch_scc1 L_flocal
  s_lshr_b32 s84, vcc_lo, 16
  s_cmp_eq_u32 s84, 7
  s_cbranch_scc1 L_ffar
  s_cmp_lt_u32 s86, 0x10000
  s_cbranch_scc1 L_f2
L_ffar:
  s_mov_b64 exec, -1
  s_add_u32 s88, s88, 0x1000000
  s_add_u32 s89, s89, 0x1000000
  s_add_u32 s90, s90, 0x1000000
  v_lshlrev_b32 v16, 4, v2
  buffer_load_dwordx4 v[32:35], v16, s[32:35], s88 offen offset:3072 sc1
  buffer_load_dwordx4 v[36:39], v16, s[32:35], s89 offen offset:3072 sc1
  buffer_load_dwordx4 v[40:43], v16, s[32:35], s90 offen offset:3072 sc1
  buffer_load_dwordx4 v[160:163], v0, s[32:35], s88 offen offset:0 sc1
  buffer_load_dwordx4 v[164:167], v0, s[32:35], s88 offen offset:1024 sc1
  buffer_load_dwordx4 v[168:171], v0, s[32:35], s88 offen offset:2048 sc1
  buffer_load_dwordx4 v[172:175], v0, s[32:35], s89 offen offset:0 sc1
  buffer_load_dwordx4 v[176:179], v0, s[32:35], s89 offen offset:1024 sc1
  buffer_load_dwordx4 v[180:183], v0, s[32:35], s89 offen offset:2048 sc1
  buffer_load_dwordx4 v[184:187], v0, s[32:35], s90 offen offset:0 sc1
  buffer_load_dwordx4 v[188:191], v0, s[32:35], s90 offen offset:1024 sc1
  buffer_load_dwordx4 v[192:195], v0, s[32:35], s90 offen offset:2048 sc1
  s_branch L_fld
L_flocal:
  s_mov_b64 exec, -1
  v_lshlrev_b32 v16, 4, v2
  buffer_load_dwordx4 v[32:35], v16, s[32:35], s88 offen offset:3072
  buffer_load_dwordx4 v[36:39], v16, s[32:35], s89 offen offset:3072
  buffer_load_dwordx4 v[40:43], v16, s[32:35], s90 offen offset:3072
  buffer_load_dwordx4 v[160:163], v0, s[32:35], s88 offen offset:0
  buffer_load_dwordx4 v[164:167], v0, s[32:35], s88 offen offset:1024
  buffer_load_dwordx4 v[168:171], v0, s[32:35], s88 offen offset:2048
  buffer_load_dwordx4 v[172:175], v0, s[32:35], s89 offen offset:0
  buffer_load_dwordx4 v[176:179], v0, s[32:35], s89 offen offset:1024
  buffer_load_dwordx4 v[180:183], v0, s[32:35], s89 offen offset:2048
  buffer_load_dwordx4 v[184:187], v0, s[32:35], s90 offen offset:0
  buffer_load_dwordx4 v[188:191], v0, s[32:35], s90 offen offset:1024
  buffer_load_dwordx4 v[192:195], v0, s[32:35], s90 offen offset:2048
L_fld:
  s_lshr_b32 s68, s61, 1
  s_mul_i32 s68, s68, 3072
  v_add_u32 v17, s68, v4
  s_xor_b32 s68, s68, 3072
  v_add_u32 v18, s68, v4
  v_add_u32 v7, 0x10000, v0
  v_add_u32 v8, 0x20000, v0
  s_mov_b32 s69, 0xffff0000
  s_waitcnt vmcnt(9)
  v_max_f32 v24, v52, v32
  v_sub_f32 v232, v52, v24
  v_sub_f32 v238, v32, v24
  v_exp_f32 v232, v232
  v_exp_f32 v238, v238
  s_nop 0
  v_add_f32 v24, v232, v238
  v_rcp_f32 v24, v24
  s_nop 0
  v_mul_f32 v232, v232, v24
  v_mul_f32 v238, v238, v24
  v_max_f32 v24, v53, v33
  v_sub_f32 v234, v53, v24
  v_sub_f32 v240, v33, v24
  v_exp_f32 v234, v234
  v_exp_f32 v240, v240
  s_nop 0
  v_add_f32 v24, v234, v240
  v_rcp_f32 v24, v24
  s_nop 0
  v_mul_f32 v234, v234, v24
  v_mul_f32 v240, v240, v24
  v_max_f32 v24, v54, v34
  v_sub_f32 v236, v54, v24
  v_sub_f32 v242, v34, v24
  v_exp_f32 v236, v236
  v_exp_f32 v242, v242
  s_nop 0
  v_add_f32 v24, v236, v242
  v_rcp_f32 v24, v24
  s_nop 0
  v_mul_f32 v236, v236, v24
  v_mul_f32 v242, v242, v24
  v_max_f32 v24, v36, v40
  v_sub_f32 v244, v36, v24
  v_sub_f32 v250, v40, v24
  v_exp_f32 v244, v244
  v_exp_f32 v250, v250
  s_nop 0
  v_add_f32 v24, v244, v250
  v_rcp_f32 v24, v24
  s_nop 0
  v_mul_f32 v244, v244, v24
  v_mul_f32 v250, v250, v24
  v_max_f32 v24, v37, v41
  v_sub_f32 v246, v37, v24
  v_sub_f32 v252, v41, v24
  v_exp_f32 v246, v246
  v_exp_f32 v252, v252
  s_nop 0
  v_add_f32 v24, v246, v252
  v_rcp_f32 v24, v24
  s_nop 0
  v_mul_f32 v246, v246, v24
  v_mul_f32 v252, v252, v24
  v_max_f32 v24, v38, v42
  v_sub_f32 v248, v38, v24
  v_sub_f32 v254, v42, v24
  v_exp_f32 v248, v248
  v_exp_f32 v254, v254
  s_nop 0
  v_add_f32 v24, v248, v254
  v_rcp_f32 v24, v24
  s_nop 0
  v_mul_f32 v248, v248, v24
  v_mul_f32 v254, v254, v24
  v_lshlrev_b32 v24, 16, v56
  v_and_b32 v25, s69, v56
  v_pk_mul_f32 v[200:201], v[24:25], v[232:233] op_sel_hi:[1,0]
  v_lshlrev_b32 v26, 16, v57
  v_and_b32 v27, s69, v57
  v_pk_mul_f32 v[202:203], v[26:27], v[232:233] op_sel_hi:[1,0]
  v_lshlrev_b32 v24, 16, v58
  v_and_b32 v25, s69, v58
  v_pk_mul_f32 v[204:205], v[24:25], v[232:233] op_sel_hi:[1,0]
  v_lshlrev_b32 v26, 16, v59
  v_and_b32 v27, s69, v59
  v_pk_mul_f32 v[206:207], v[26:27], v[232:233] op_sel_hi:[1,0]
  v_lshlrev_b32 v24, 16, v60
  v_and_b32 v25, s69, v60
  v_pk_mul_f32 v[208:209], v[24:25], v[234:235] op_sel_hi:[1,0]
  v_lshlrev_b32 v26, 16, v61
  v_and_b32 v27, s69, v61
  v_pk_mul_f32 v[210:211], v[26:27], v[234:235] op_sel_hi:[1,0]
  v_lshlrev_b32 v24, 16, v62
  v_and_b32 v25, s69, v62
  v_pk_mul_f32 v[212:213], v[24:25], v[234:235] op_sel_hi:[1,0]
  v_lshlrev_b32 v26, 16, v63
  v_and_b32 v27, s69, v63
  v_pk_mul_f32 v[214:215], v[26:27], v[234:235] op_sel_hi:[1,0]
  v_lshlrev_b32 v24, 16, v64
  v_and_b32 v25, s69, v64
  v_pk_mul_f32 v[216:217], v[24:25], v[236:237] op_sel_hi:[1,0]
  v_lshlrev_b32 v26, 16, v65
  v_and_b32 v27, s69, v65
  v_pk_mul_f32 v[218:219], v[26:27], v[236:237] op_sel_hi:[1,0]
  v_lshlrev_b32 v24, 16, v66
  v_and_b32 v25, s69, v66
  v_pk_mul_f32 v[220:221], v[24:25], v[236:237] op_sel_hi:[1,0]
  v_lshlrev_b32 v26, 16, v67
  v_and_b32 v27, s69, v67
  v_pk_mul_f32 v[222:223], v[26:27], v[236:237] op_sel_hi:[1,0]
  s_waitcnt vmcnt(6)
  v_lshlrev_b32 v24, 16, v160
  v_and_b32 v25, s69, v160
  v_pk_fma_f32 v[200:201], v[24:25], v[238:239], v[200:201] op_sel_hi:[1,0,1]
  v_lshlrev_b32 v26, 16, v161
  v_and_b32 v27, s69, v161
  v_pk_fma_f32 v[202:203], v[26:27], v[238:239], v[202:203] op_sel_hi:[1,0,1]
  v_lshlrev_b32 v24, 16, v162
  v_and_b32 v25, s69, v162
  v_pk_fma_f32 v[204:205], v[24:25], v[238:239], v[204:205] op_sel_hi:[1,0,1]
  v_lshlrev_b32 v26, 16, v163
  v_and_b32 v27, s69, v163
  v_pk_fma_f32 v[206:207], v[26:27], v[238:239], v[206:207] op_sel_hi:[1,0,1]
  v_lshlrev_b32 v24, 16, v164
  v_and_b32 v25, s69, v164
  v_pk_fma_f32 v[208:209], v[24:25], v[240:241], v[208:209] op_sel_hi:[1,0,1]
  v_lshlrev_b32 v26, 16, v165
  v_and_b32 v27, s69, v165
  v_pk_fma_f32 v[210:211], v[26:27], v[240:241], v[210:211] op_sel_hi:[1,0,1]
  v_lshlrev_b32 v24, 16, v166
  v_and_b32 v25, s69, v166
  v_pk_fma_f32 v[212:213], v[24:25], v[240:241], v[212:213] op_sel_hi:[1,0,1]
  v_lshlrev_b32 v26, 16, v167
  v_and_b32 v27, s69, v167
  v_pk_fma_f32 v[214:215], v[26:27], v[240:241], v[214:215] op_sel_hi:[1,0,1]
  v_lshlrev_b32 v24, 16, v168
  v_and_b32 v25, s69, v168
  v_pk_fma_f32 v[216:217], v[24:25], v[242:243], v[216:217] op_sel_hi:[1,0,1]
  v_lshlrev_b32 v26, 16, v169
  v_and_b32 v27, s69, v169
  v_pk_fma_f32 v[218:219], v[26:27], v[242:243], v[218:219] op_sel_hi:[1,0,1]
  v_lshlrev_b32 v24, 16, v170
  v_and_b32 v25, s69, v170
  v_pk_fma_f32 v[220:221], v[24:25], v[242:243], v[220:221] op_sel_hi:[1,0,1]
  v_lshlrev_b32 v26, 16, v171
  v_and_b32 v27, s69, v171
  v_pk_fma_f32 v[222:223], v[26:27], v[242:243], v[222:223] op_sel_hi:[1,0,1]
  v_cvt_pk_bf16_f32 v72, v200, v201
  v_cvt_pk_bf16_f32 v73, v202, v203
  v_cvt_pk_bf16_f32 v74, v204, v205
  v_cvt_pk_bf16_f32 v75, v206, v207
  ds_write_b128 v17, v[72:75] offset:0
  v_cvt_pk_bf16_f32 v76, v208, v209
  v_cvt_pk_bf16_f32 v77, v210, v211
  v_cvt_pk_bf16_f32 v78, v212, v213
  v_cvt_pk_bf16_f32 v79, v214, v215
  ds_write_b128 v17, v[76:79] offset:1024
  v_cvt_pk_bf16_f32 v80, v216, v217
  v_cvt_pk_bf16_f32 v81, v218, v219
  v_cvt_pk_bf16_f32 v82, v220, v221
  v_cvt_pk_bf16_f32 v83, v222, v223
  ds_write_b128 v17, v[80:83] offset:2048
  s_waitcnt vmcnt(3)
  v_lshlrev_b32 v24, 16, v172
  v_and_b32 v25, s69, v172
  v_pk_mul_f32 v[200:201], v[24:25], v[244:245] op_sel_hi:[1,0]
  v_lshlrev_b32 v26, 16, v173
  v_and_b32 v27, s69, v173
  v_pk_mul_f32 v[202:203], v[26:27], v[244:245] op_sel_hi:[1,0]
  v_lshlrev_b32 v24, 16, v174
  v_and_b32 v25, s69, v174
  v_pk_mul_f32 v[204:205], v[24:25], v[244:245] op_sel_hi:[1,0]
  v_lshlrev_b32 v26, 16, v175
  v_and_b32 v27, s69, v175
  v_pk_mul_f32 v[206:207], v[26:27], v[244:245] op_sel_hi:[1,0]
  v_lshlrev_b32 v24, 16, v176
  v_and_b32 v25, s69, v176
  v_pk_mul_f32 v[208:209], v[24:25], v[246:247] op_sel_hi:[1,0]
  v_lshlrev_b32 v26, 16, v177
  v_and_b32 v27, s69, v177
  v_pk_mul_f32 v[210:211], v[26:27], v[246:247] op_sel_hi:[1,0]
  v_lshlrev_b32 v24, 16, v178
  v_and_b32 v25, s69, v178
  v_pk_mul_f32 v[212:213], v[24:25], v[246:247] op_sel_hi:[1,0]
  v_lshlrev_b32 v26, 16, v179
  v_and_b32 v27, s69, v179
  v_pk_mul_f32 v[214:215], v[26:27], v[246:247] op_sel_hi:[1,0]
  v_lshlrev_b32 v24, 16, v180
  v_and_b32 v25, s69, v180
  v_pk_mul_f32 v[216:217], v[24:25], v[248:249] op_sel_hi:[1,0]
  v_lshlrev_b32 v26, 16, v181
  v_and_b32 v27, s69, v181
  v_pk_mul_f32 v[218:219], v[26:27], v[248:249] op_sel_hi:[1,0]
  v_lshlrev_b32 v24, 16, v182
  v_and_b32 v25, s69, v182
  v_pk_mul_f32 v[220:221], v[24:25], v[248:249] op_sel_hi:[1,0]
  v_lshlrev_b32 v26, 16, v183
  v_and_b32 v27, s69, v183
  v_pk_mul_f32 v[222:223], v[26:27], v[248:249] op_sel_hi:[1,0]
  s_waitcnt vmcnt(0)
  v_lshlrev_b32 v24, 16, v184
  v_and_b32 v25, s69, v184
  v_pk_fma_f32 v[200:201], v[24:25], v[250:251], v[200:201] op_sel_hi:[1,0,1]
  v_lshlrev_b32 v26, 16, v185
  v_and_b32 v27, s69, v185
  v_pk_fma_f32 v[202:203], v[26:27], v[250:251], v[202:203] op_sel_hi:[1,0,1]
  v_lshlrev_b32 v24, 16, v186
  v_and_b32 v25, s69, v186
  v_pk_fma_f32 v[204:205], v[24:25], v[250:251], v[204:205] op_sel_hi:[1,0,1]
  v_lshlrev_b32 v26, 16, v187
  v_and_b32 v27, s69, v187
  v_pk_fma_f32 v[206:207], v[26:27], v[250:251], v[206:207] op_sel_hi:[1,0,1]
  v_lshlrev_b32 v24, 16, v188
  v_and_b32 v25, s69, v188
  v_pk_fma_f32 v[208:209], v[24:25], v[252:253], v[208:209] op_sel_hi:[1,0,1]
  v_lshlrev_b32 v26, 16, v189
  v_and_b32 v27, s69, v189
  v_pk_fma_f32 v[210:211], v[26:27], v[252:253], v[210:211] op_sel_hi:[1,0,1]
  v_lshlrev_b32 v24, 16, v190
  v_and_b32 v25, s69, v190
  v_pk_fma_f32 v[212:213], v[24:25], v[252:253], v[212:213] op_sel_hi:[1,0,1]
  v_lshlrev_b32 v26, 16, v191
  v_and_b32 v27, s69, v191
  v_pk_fma_f32 v[214:215], v[26:27], v[252:253], v[214:215] op_sel_hi:[1,0,1]
  v_lshlrev_b32 v24, 16, v192
  v_and_b32 v25, s69, v192
  v_pk_fma_f32 v[216:217], v[24:25], v[254:255], v[216:217] op_sel_hi:[1,0,1]
  v_lshlrev_b32 v26, 16, v193
  v_and_b32 v27, s69, v193
  v_pk_fma_f32 v[218:219], v[26:27], v[254:255], v[218:219] op_sel_hi:[1,0,1]
  v_lshlrev_b32 v24, 16, v194
  v_and_b32 v25, s69, v194
  v_pk_fma_f32 v[220:221], v[24:25], v[254:255], v[220:221] op_sel_hi:[1,0,1]
  v_lshlrev_b32 v26, 16, v195
  v_and_b32 v27, s69, v195
  v_pk_fma_f32 v[222:223], v[26:27], v[254:255], v[222:223] op_sel_hi:[1,0,1]
  v_cvt_pk_bf16_f32 v88, v200, v201
  v_cvt_pk_bf16_f32 v89, v202, v203
  v_cvt_pk_bf16_f32 v90, v204, v205
  v_cvt_pk_bf16_f32 v91, v206, v207
  ds_write_b128 v18, v[88:91] offset:0
  v_cvt_pk_bf16_f32 v92, v208, v209
  v_cvt_pk_bf16_f32 v93, v210, v211
  v_cvt_pk_bf16_f32 v94, v212, v213
  v_cvt_pk_bf16_f32 v95, v214, v215
  ds_write_b128 v18, v[92:95] offset:1024
  v_cvt_pk_bf16_f32 v96, v216, v217
  v_cvt_pk_bf16_f32 v97, v218, v219
  v_cvt_pk_bf16_f32 v98, v220, v221
  v_cvt_pk_bf16_f32 v99, v222, v223
  ds_write_b128 v18, v[96:99] offset:2048
  s_waitcnt lgkmcnt(0)
  s_barrier
  ds_read_b128 v[160:163], v0 offset:0
  ds_read_b128 v[164:167], v0 offset:1024
  ds_read_b128 v[168:171], v0 offset:2048
  ds_read_b128 v[172:175], v0 offset:24576
  ds_read_b128 v[176:179], v0 offset:25600
  ds_read_b128 v[180:183], v0 offset:26624
  ds_read_b128 v[184:187], v0 offset:49152
  ds_read_b128 v[188:191], v0 offset:50176
  ds_read_b128 v[192:195], v0 offset:51200
  ds_read_b128 v[196:199], v8 offset:12288
  ds_read_b128 v[200:203], v8 offset:13312
  ds_read_b128 v[204:207], v8 offset:14336
  s_waitcnt lgkmcnt(9)
  v_mfma_f32_16x16x32_bf16 v[100:103], v[112:115], v[160:163], 0
  v_mfma_f32_16x16x32_bf16 v[104:107], v[112:115], v[164:167], 0
  v_mfma_f32_16x16x32_bf16 v[108:111], v[112:115], v[168:171], 0
  ds_read_b128 v[208:211], v0 offset:12288
  ds_read_b128 v[212:215], v0 offset:13312
  ds_read_b128 v[216:219], v0 offset:14336
  ds_read_b64_tr_b16 v[32:33], v6 offset:0
  ds_read_b64_tr_b16 v[34:35], v6 offset:4096
  s_waitcnt lgkmcnt(11)
  v_mfma_f32_16x16x32_bf16 v[100:103], v[116:119], v[172:175], v[100:103]
  v_mfma_f32_16x16x32_bf16 v[104:107], v[116:119], v[176:179], v[104:107]
  v_mfma_f32_16x16x32_bf16 v[108:111], v[116:119], v[180:183], v[108:111]
  ds_read_b128 v[220:223], v0 offset:36864
  ds_read_b128 v[224:227], v0 offset:37888
  ds_read_b128 v[228:231], v0 offset:38912
  ds_read_b64_tr_b16 v[36:37], v6 offset:8192
  ds_read_b64_tr_b16 v[38:39], v6 offset:12288
  s_waitcnt lgkmcnt(13)
  v_mfma_f32_16x16x32_bf16 v[100:103], v[120:123], v[184:187], v[100:103]
  v_mfma_f32_16x16x32_bf16 v[104:107], v[120:123], v[188:191], v[104:107]
  v_mfma_f32_16x16x32_bf16 v[108:111], v[120:123], v[192:195], v[108:111]
  ds_read_b128 v[232:235], v8 offset:0
  ds_read_b128 v[236:239], v8 offset:1024
  ds_read_b128 v[240:243], v8 offset:2048
  ds_read_b64_tr_b16 v[40:41], v6 offset:16384
  ds_read_b64_tr_b16 v[42:43], v6 offset:20480
  s_waitcnt lgkmcnt(15)
  v_mfma_f32_16x16x32_bf16 v[100:103], v[124:127], v[196:199], v[100:103]
  v_mfma_f32_16x16x32_bf16 v[104:107], v[124:127], v[200:203], v[104:107]
  v_mfma_f32_16x16x32_bf16 v[108:111], v[124:127], v[204:207], v[108:111]
  ds_read_b128 v[244:247], v7 offset:16384
  ds_read_b128 v[248:251], v7 offset:17408
  ds_read_b128 v[252:255], v7 offset:18432
  ds_read_b64_tr_b16 v[44:45], v6 offset:24576
  ds_read_b64_tr_b16 v[46:47], v6 offset:28672
  s_waitcnt lgkmcnt(15)
  v_mfma_f32_16x16x32_bf16 v[100:103], v[128:131], v[208:211], v[100:103]
  v_mfma_f32_16x16x32_bf16 v[104:107], v[128:131], v[212:215], v[104:107]
  v_mfma_f32_16x16x32_bf16 v[108:111], v[128:131], v[216:219], v[108:111]
  ds_read_b128 v[160:163], v0 offset:3072
  ds_read_b128 v[164:167], v0 offset:4096
  ds_read_b128 v[168:171], v0 offset:5120
  s_waitcnt lgkmcnt(13)
  v_mfma_f32_16x16x32_bf16 v[100:103], v[132:135], v[220:223], v[100:103]
  v_mfma_f32_16x16x32_bf16 v[104:107], v[132:135], v[224:227], v[104:107]
  v_mfma_f32_16x16x32_bf16 v[108:111], v[132:135], v[228:231], v[108:111]
  ds_read_b128 v[172:175], v0 offset:27648
  ds_read_b128 v[176:179], v0 offset:28672
  ds_read_b128 v[180:183], v0 offset:29696
  s_waitcnt lgkmcnt(11)
  v_mfma_f32_16x16x32_bf16 v[100:103], v[136:139], v[232:235], v[100:103]
  v_mfma_f32_16x16x32_bf16 v[104:107], v[136:139], v[236:239], v[104:107]
  v_mfma_f32_16x16x32_bf16 v[108:111], v[136:139], v[240:243], v[108:111]
  ds_read_b128 v[184:187], v0 offset:52224
  ds_read_b128 v[188:191], v0 offset:53248
  ds_read_b128 v[192:195], v0 offset:54272
  s_waitcnt lgkmcnt(9)
  v_mfma_f32_16x16x32_bf16 v[100:103], v[140:143], v[244:247], v[100:103]
  v_mfma_f32_16x16x32_bf16 v[104:107], v[140:143], v[248:251], v[104:107]
  v_mfma_f32_16x16x32_bf16 v[108:111], v[140:143], v[252:255], v[108:111]
  ds_read_b128 v[196:199], v8 offset:15360
  ds_read_b128 v[200:203], v8 offset:16384
  ds_read_b128 v[204:207], v8 offset:17408
  s_waitcnt lgkmcnt(9)
  v_mfma_f32_16x16x32_bf16 v[100:103], v[144:147], v[160:163], v[100:103]
  v_mfma_f32_16x16x32_bf16 v[104:107], v[144:147], v[164:167], v[104:107]
  v_mfma_f32_16x16x32_bf16 v[108:111], v[144:147], v[168:171], v[108:111]
  ds_read_b128 v[208:211], v0 offset:15360
  ds_read_b128 v[212:215], v0 offset:16384
  ds_read_b128 v[216:219], v0 offset:17408
  s_waitcnt lgkmcnt(9)
  v_mfma_f32_16x16x32_bf16 v[100:103], v[148:151], v[172:175], v[100:103]
  v_mfma_f32_16x16x32_bf16 v[104:107], v[148:151], v[176:179], v[104:107]
  v_mfma_f32_16x16x32_bf16 v[108:111], v[148:151], v[180:183], v[108:111]
  ds_read_b128 v[220:223], v0 offset:39936
  ds_read_b128 v[224:227], v0 offset:40960
  ds_read_b128 v[228:231], v0 offset:41984
  s_waitcnt lgkmcnt(9)
  v_mfma_f32_16x16x32_bf16 v[100:103], v[152:155], v[184:187], v[100:103]
  v_mfma_f32_16x16x32_bf16 v[104:107], v[152:155], v[188:191], v[104:107]
  v_mfma_f32_16x16x32_bf16 v[108:111], v[152:155], v[192:195], v[108:111]
  ds_read_b128 v[232:235], v8 offset:3072
  ds_read_b128 v[236:239], v8 offset:4096
  ds_read_b128 v[240:243], v8 offset:5120
  s_waitcnt lgkmcnt(9)
  v_mfma_f32_16x16x32_bf16 v[100:103], v[156:159], v[196:199], v[100:103]
  v_mfma_f32_16x16x32_bf16 v[104:107], v[156:159], v[200:203], v[104:107]
  v_mfma_f32_16x16x32_bf16 v[108:111], v[156:159], v[204:207], v[108:111]
  ds_read_b128 v[244:247], v7 offset:19456
  ds_read_b128 v[248:251], v7 offset:20480
  ds_read_b128 v[252:255], v7 offset:21504
  s_waitcnt lgkmcnt(9)
  v_mfma_f32_16x16x32_bf16 v[100:103], v[32:35], v[208:211], v[100:103]
  v_mfma_f32_16x16x32_bf16 v[104:107], v[32:35], v[212:215], v[104:107]
  v_mfma_f32_16x16x32_bf16 v[108:111], v[32:35], v[216:219], v[108:111]
  s_waitcnt lgkmcnt(6)
  v_mfma_f32_16x16x32_bf16 v[100:103], v[36:39], v[220:223], v[100:103]
  v_mfma_f32_16x16x32_bf16 v[104:107], v[36:39], v[224:227], v[104:107]
  v_mfma_f32_16x16x32_bf16 v[108:111], v[36:39], v[228:231], v[108:111]
  s_waitcnt lgkmcnt(3)
  v_mfma_f32_16x16x32_bf16 v[100:103], v[40:43], v[232:235], v[100:103]
  v_mfma_f32_16x16x32_bf16 v[104:107], v[40:43], v[236:239], v[104:107]
  v_mfma_f32_16x16x32_bf16 v[108:111], v[40:43], v[240:243], v[108:111]
  s_waitcnt lgkmcnt(0)
  v_mfma_f32_16x16x32_bf16 v[100:103], v[44:47], v[244:247], v[100:103]
  v_mfma_f32_16x16x32_bf16 v[104:107], v[44:47], v[248:251], v[104:107]
  v_mfma_f32_16x16x32_bf16 v[108:111], v[44:47], v[252:255], v[108:111]
  s_and_b32 s88, s64, 0xfff
  s_bfe_u32 s89, s64, 0xc000c
  s_lshr_b64 s[66:67], s[64:65], 24
  s_and_b32 s90, s66, 0xfff
  s_bfe_u32 s91, s66, 0xc000c
  v_mov_b32 v24, 0xfff
  s_lshl_b32 s66, s2, 3
  s_add_u32 s66, s66, s56
  s_mul_i32 s66, s66, 3072
  s_add_u32 s66, s66, 33554432
  s_mul_i32 s67, s57, 3072
  s_add_u32 s67, s67, 65536
  v_add_u32 v17, s67, v0
  v_add_u32 v100, 0x800, v100
  v_bfi_b32 v100, v24, s88, v100
  v_add_u32 v101, 0x800, v101
  v_bfi_b32 v101, v24, s89, v101
  v_add_u32 v102, 0x800, v102
  v_bfi_b32 v102, v24, s90, v102
  v_add_u32 v103, 0x800, v103
  v_bfi_b32 v103, v24, s91, v103
  v_add_u32 v104, 0x800, v104
  v_bfi_b32 v104, v24, s88, v104
  v_add_u32 v105, 0x800, v105
  v_bfi_b32 v105, v24, s89, v105
  v_add_u32 v106, 0x800, v106
  v_bfi_b32 v106, v24, s90, v106
  v_add_u32 v107, 0x800, v107
  v_bfi_b32 v107, v24, s91, v107
  v_add_u32 v108, 0x800, v108
  v_bfi_b32 v108, v24, s88, v108
  v_add_u32 v109, 0x800, v109
  v_bfi_b32 v109, v24, s89, v109
  v_add_u32 v110, 0x800, v110
  v_bfi_b32 v110, v24, s90, v110
  v_add_u32 v111, 0x800, v111
  v_bfi_b32 v111, v24, s91, v111
  s_cmp_lg_u32 s58, 0
  s_cbranch_scc1 L_y1
  ds_write_b128 v17, v[100:103] offset:0
  ds_write_b128 v17, v[104:107] offset:1024
  ds_write_b128 v17, v[108:111] offset:2048
  s_waitcnt lgkmcnt(0)
  s_barrier
  s_branch L_y2
L_y1:
  buffer_store_dwordx4 v[100:103], v0, s[32:35], s66 offen offset:0 sc1
  buffer_store_dwordx4 v[104:107], v0, s[32:35], s66 offen offset:1024 sc1
  buffer_store_dwordx4 v[108:111], v0, s[32:35], s66 offen offset:2048 sc1
  s_barrier
  ds_read_b128 v[160:163], v17 offset:0
  ds_read_b128 v[164:167], v17 offset:1024
  ds_read_b128 v[168:171], v17 offset:2048
  s_sub_u32 s66, s66, 12288
  s_waitcnt lgkmcnt(0)
  buffer_store_dwordx4 v[160:163], v0, s[32:35], s66 offen offset:0 sc1
  buffer_store_dwordx4 v[164:167], v0, s[32:35], s66 offen offset:1024 sc1
  buffer_store_dwordx4 v[168:171], v0, s[32:35], s66 offen offset:2048 sc1
  s_endpgm
L_y2:
  s_cmp_ge_u32 s56, 3
  s_cbranch_scc1 L_end
  s_andn2_b32 s66, s2, 7
  s_lshl_b32 s66, s66, 3
  s_add_u32 s66, s66, s59
  s_mul_i32 s66, s66, 3072
  s_lshl_b32 s67, s56, 10
  s_add_u32 s66, s66, s67
  s_add_u32 s66, s66, 33554432
  s_mov_b32 s86, 0
  s_mov_b32 s69, 0xfffff000
  v_mul_u32_u24 v15, 24576, v1
  v_add_u32 v15, 1008, v15
  s_mov_b64 exec, 0xff
L_ysent:
  buffer_load_dwordx4 v[28:31], v15, s[32:35], s66 offen sc1
  s_add_u32 s86, s86, 1
  s_waitcnt vmcnt(0)
  v_xor_b32 v25, s88, v28
  v_bitop3_b32 v25, v25, v29, s89 bitop3:0xf6
  v_bitop3_b32 v25, v25, v30, s90 bitop3:0xf6
  v_and_b32 v25, v25, v24
  v_cmp_ne_u32 vcc, 0, v25
  s_cmp_gt_u32 s86, 0x10000
  s_cbranch_scc1 L_ysent_x
  s_cbranch_vccnz L_ysent
L_ysent_x:
  s_mov_b64 exec, -1
  s_mov_b32 s86, 0
L_ypoll:
  s_mov_b32 s67, s66
  buffer_load_dwordx4 v[160:163], v0, s[32:35], s67 offen sc1
  s_add_u32 s67, s67, 24576
  buffer_load_dwordx4 v[164:167], v0, s[32:35], s67 offen sc1
  s_add_u32 s67, s67, 24576
  buffer_load_dwordx4 v[168:171], v0, s[32:35], s67 offen sc1
  s_add_u32 s67, s67, 24576
  buffer_load_dwordx4 v[172:175], v0, s[32:35], s67 offen sc1
  s_add_u32 s67, s67, 24576
  buffer_load_dwordx4 v[176:179], v0, s[32:35], s67 offen sc1
  s_add_u32 s67, s67, 24576
  buffer_load_dwordx4 v[180:183], v0, s[32:35], s67 offen sc1
  s_add_u32 s67, s67, 24576
  buffer_load_dwordx4 v[184:187], v0, s[32:35], s67 offen sc1
  s_add_u32 s67, s67, 24576
  buffer_load_dwordx4 v[188:191], v0, s[32:35], s67 offen sc1
  v_mov_b32 v25, 0
  v_mov_b32 v26, 0
  v_mov_b32 v27, 0
  v_mov_b32 v28, 0
  s_waitcnt vmcnt(6)
  v_bitop3_b32 v25, v25, v160, s88 bitop3:0xf6
  v_and_b32 v112, s69, v160
  v_bitop3_b32 v26, v26, v161, s89 bitop3:0xf6
  v_and_b32 v113, s69, v161
  v_bitop3_b32 v27, v27, v162, s90 bitop3:0xf6
  v_and_b32 v114, s69, v162
  v_bitop3_b32 v28, v28, v163, s91 bitop3:0xf6
  v_and_b32 v115, s69, v163
  v_bitop3_b32 v25, v25, v164, s88 bitop3:0xf6
  v_and_b32 v164, s69, v164
  v_add_f32 v112, v112, v164
  v_bitop3_b32 v26, v26, v165, s89 bitop3:0xf6
  v_and_b32 v165, s69, v165
  v_add_f32 v113, v113, v165
  v_bitop3_b32 v27, v27, v166, s90 bitop3:0xf6
  v_and_b32 v166, s69, v166
  v_add_f32 v114, v114, v166
  v_bitop3_b32 v28, v28, v167, s91 bitop3:0xf6
  v_and_b32 v167, s69, v167
  v_add_f32 v115, v115, v167
  s_waitcnt vmcnt(4)
  v_bitop3_b32 v25, v25, v168, s88 bitop3:0xf6
  v_and_b32 v168, s69, v168
  v_add_f32 v112, v112, v168
  v_bitop3_b32 v26, v26, v169, s89 bitop3:0xf6
  v_and_b32 v169, s69, v169
  v_add_f32 v113, v113, v169
  v_bitop3_b32 v27, v27, v170, s90 bitop3:0xf6
  v_and_b32 v170, s69, v170
  v_add_f32 v114, v114, v170
  v_bitop3_b32 v28, v28, v171, s91 bitop3:0xf6
  v_and_b32 v171, s69, v171
  v_add_f32 v115, v115, v171
  v_bitop3_b32 v25, v25, v172, s88 bitop3:0xf6
  v_and_b32 v172, s69, v172
  v_add_f32 v112, v112, v172
  v_bitop3_b32 v26, v26, v173, s89 bitop3:0xf6
  v_and_b32 v173, s69, v173
  v_add_f32 v113, v113, v173
  v_bitop3_b32 v27, v27, v174, s90 bitop3:0xf6
  v_and_b32 v174, s69, v174
  v_add_f32 v114, v114, v174
  v_bitop3_b32 v28, v28, v175, s91 bitop3:0xf6
  v_and_b32 v175, s69, v175
  v_add_f32 v115, v115, v175
  s_waitcnt vmcnt(2)
  v_bitop3_b32 v25, v25, v176, s88 bitop3:0xf6
  v_and_b32 v176, s69, v176
  v_add_f32 v112, v112, v176
  v_bitop3_b32 v26, v26, v177, s89 bitop3:0xf6
  v_and_b32 v177, s69, v177
  v_add_f32 v113, v113, v177
  v_bitop3_b32 v27, v27, v178, s90 bitop3:0xf6
  v_and_b32 v178, s69, v178
  v_add_f32 v114, v114, v178
  v_bitop3_b32 v28, v28, v179, s91 bitop3:0xf6
  v_and_b32 v179, s69, v179
  v_add_f32 v115, v115, v179
  v_bitop3_b32 v25, v25, v180, s88 bitop3:0xf6
  v_and_b32 v180, s69, v180
  v_add_f32 v112, v112, v180
  v_bitop3_b32 v26, v26, v181, s89 bitop3:0xf6
  v_and_b32 v181, s69, v181
  v_add_f32 v113, v113, v181
  v_bitop3_b32 v27, v27, v182, s90 bitop3:0xf6
  v_and_b32 v182, s69, v182
  v_add_f32 v114, v114, v182
  v_bitop3_b32 v28, v28, v183, s91 bitop3:0xf6
  v_and_b32 v183, s69, v183
  v_add_f32 v115, v115, v183
  s_waitcnt vmcnt(0)
  v_bitop3_b32 v25, v25, v184, s88 bitop3:0xf6
  v_and_b32 v184, s69, v184
  v_add_f32 v112, v112, v184
  v_bitop3_b32 v26, v26, v185, s89 bitop3:0xf6
  v_and_b32 v185, s69, v185
  v_add_f32 v113, v113, v185
  v_bitop3_b32 v27, v27, v186, s90 bitop3:0xf6
  v_and_b32 v186, s69, v186
  v_add_f32 v114, v114, v186
  v_bitop3_b32 v28, v28, v187, s91 bitop3:0xf6
  v_and_b32 v187, s69, v187
  v_add_f32 v115, v115, v187
  v_bitop3_b32 v25, v25, v188, s88 bitop3:0xf6
  v_and_b32 v188, s69, v188
  v_add_f32 v112, v112, v188
  v_bitop3_b32 v26, v26, v189, s89 bitop3:0xf6
  v_and_b32 v189, s69, v189
  v_add_f32 v113, v113, v189
  v_bitop3_b32 v27, v27, v190, s90 bitop3:0xf6
  v_and_b32 v190, s69, v190
  v_add_f32 v114, v114, v190
  v_bitop3_b32 v28, v28, v191, s91 bitop3:0xf6
  v_and_b32 v191, s69, v191
  v_add_f32 v115, v115, v191
  v_or3_b32 v25, v25, v26, v27
  v_or_b32 v25, v25, v28
  v_and_b32 v25, v25, v24
  v_cmp_ne_u32 vcc, 0, v25
  s_cbranch_vccz L_yok
  s_add_u32 s86, s86, 1
  s_cmp_lt_u32 s86, 0x10000
  s_cbranch_scc1 L_ypoll
L_yok:
  v_cvt_pk_bf16_f32 v26, v112, v113
  v_cvt_pk_bf16_f32 v27, v114, v115
  v_lshlrev_b32 v15, 10, v2
  v_lshl_add_u32 v15, v3, 3, v15
  s_mul_i32 s66, s60, 49152
  s_lshl_b32 s67, s56, 14
  s_add_u32 s66, s66, s67
  s_lshl_b32 s67, s61, 8
  s_add_u32 s66, s66, s67
  s_lshl_b32 s67, s59, 5
  s_add_u32 s66, s66, s67
  buffer_store_dwordx2 v[26:27], v15, s[24:27], s66 offen
L_end:
  s_endpgm
L_rescale0:
  s_nop 7
  v_max3_f32 v24, v88, v89, v90
  v_max3_f32 v24, v24, v91, v100
  v_max3_f32 v24, v24, v101, v102
  v_max_f32 v24, v24, v103
  v_mov_b32 v30, v24
  v_mov_b32 v31, v24
  s_nop 1
  v_permlane16_swap_b32 v30, v31
  s_nop 1
  v_max_f32 v30, v30, v31
  v_mov_b32 v31, v30
  s_nop 1
  v_permlane32_swap_b32 v30, v31
  s_nop 1
  v_max_f32 v24, v30, v31
  v_max_f32 v24, 0, v24
  v_sub_f32 v25, 0, v24
  v_exp_f32 v25, v25
  v_sub_f32 v32, v32, v24
  v_sub_f32 v33, v33, v24
  v_sub_f32 v34, v34, v24
  v_sub_f32 v35, v35, v24
  v_sub_f32 v88, v88, v24
  v_sub_f32 v89, v89, v24
  v_sub_f32 v90, v90, v24
  v_sub_f32 v91, v91, v24
  v_sub_f32 v100, v100, v24
  v_sub_f32 v101, v101, v24
  v_sub_f32 v102, v102, v24
  v_sub_f32 v103, v103, v24
  v_mul_f32 v9, v9, v25
  v_mul_f32 v160, v160, v25
  v_mul_f32 v161, v161, v25
  v_mul_f32 v162, v162, v25
  v_mul_f32 v163, v163, v25
  v_mul_f32 v172, v172, v25
  v_mul_f32 v173, v173, v25
  v_mul_f32 v174, v174, v25
  v_mul_f32 v175, v175, v25
  v_mul_f32 v184, v184, v25
  v_mul_f32 v185, v185, v25
  v_mul_f32 v186, v186, v25
  v_mul_f32 v187, v187, v25
  v_mul_f32 v196, v196, v25
  v_mul_f32 v197, v197, v25
  v_mul_f32 v198, v198, v25
  v_mul_f32 v199, v199, v25
  v_mul_f32 v208, v208, v25
  v_mul_f32 v209, v209, v25
  v_mul_f32 v210, v210, v25
  v_mul_f32 v211, v211, v25
  v_mul_f32 v220, v220, v25
  v_mul_f32 v221, v221, v25
  v_mul_f32 v222, v222, v25
  v_mul_f32 v223, v223, v25
  v_mul_f32 v232, v232, v25
  v_mul_f32 v233, v233, v25
  v_mul_f32 v234, v234, v25
  v_mul_f32 v235, v235, v25
  v_mul_f32 v244, v244, v25
  v_mul_f32 v245, v245, v25
  v_mul_f32 v246, v246, v25
  v_mul_f32 v247, v247, v25
  v_exp_f32 v24, v88
  v_exp_f32 v25, v89
  v_exp_f32 v26, v90
  v_exp_f32 v27, v91
  v_add_f32 v12, v24, v25
  v_cvt_pk_bf16_f32 v44, v24, v25
  v_add_f32 v12, v12, v26
  v_exp_f32 v28, v100
  v_exp_f32 v29, v101
  v_cvt_pk_bf16_f32 v45, v26, v27
  v_add_f32 v12, v12, v27
  v_exp_f32 v30, v102
  v_exp_f32 v31, v103
  v_add_f32 v12, v12, v28
  v_cvt_pk_bf16_f32 v46, v28, v29
  v_add_f32 v12, v12, v29
  v_add_f32 v12, v12, v30
  v_cvt_pk_bf16_f32 v47, v30, v31
  v_add_f32 v12, v12, v31
  s_nop 1
  s_setpc_b64 s[76:77]
L_rescale1:
  s_nop 7
  v_max3_f32 v24, v92, v93, v94
  v_max3_f32 v24, v24, v95, v104
  v_max3_f32 v24, v24, v105, v106
  v_max_f32 v24, v24, v107
  v_mov_b32 v30, v24
  v_mov_b32 v31, v24
  s_nop 1
  v_permlane16_swap_b32 v30, v31
  s_nop 1
  v_max_f32 v30, v30, v31
  v_mov_b32 v31, v30
  s_nop 1
  v_permlane32_swap_b32 v30, v31
  s_nop 1
  v_max_f32 v24, v30, v31
  v_max_f32 v24, 0, v24
  v_sub_f32 v25, 0, v24
  v_exp_f32 v25, v25
  v_sub_f32 v36, v36, v24
  v_sub_f32 v37, v37, v24
  v_sub_f32 v38, v38, v24
  v_sub_f32 v39, v39, v24
  v_sub_f32 v92, v92, v24
  v_sub_f32 v93, v93, v24
  v_sub_f32 v94, v94, v24
  v_sub_f32 v95, v95, v24
  v_sub_f32 v104, v104, v24
  v_sub_f32 v105, v105, v24
  v_sub_f32 v106, v106, v24
  v_sub_f32 v107, v107, v24
  v_mul_f32 v10, v10, v25
  v_mul_f32 v164, v164, v25
  v_mul_f32 v165, v165, v25
  v_mul_f32 v166, v166, v25
  v_mul_f32 v167, v167, v25
  v_mul_f32 v176, v176, v25
  v_mul_f32 v177, v177, v25
  v_mul_f32 v178, v178, v25
  v_mul_f32 v179, v179, v25
  v_mul_f32 v188, v188, v25
  v_mul_f32 v189, v189, v25
  v_mul_f32 v190, v190, v25
  v_mul_f32 v191, v191, v25
  v_mul_f32 v200, v200, v25
  v_mul_f32 v201, v201, v25
  v_mul_f32 v202, v202, v25
  v_mul_f32 v203, v203, v25
  v_mul_f32 v212, v212, v25
  v_mul_f32 v213, v213, v25
  v_mul_f32 v214, v214, v25
  v_mul_f32 v215, v215, v25
  v_mul_f32 v224, v224, v25
  v_mul_f32 v225, v225, v25
  v_mul_f32 v226, v226, v25
  v_mul_f32 v227, v227, v25
  v_mul_f32 v236, v236, v25
  v_mul_f32 v237, v237, v25
  v_mul_f32 v238, v238, v25
  v_mul_f32 v239, v239, v25
  v_mul_f32 v248, v248, v25
  v_mul_f32 v249, v249, v25
  v_mul_f32 v250, v250, v25
  v_mul_f32 v251, v251, v25
  v_exp_f32 v24, v92
  v_exp_f32 v25, v93
  v_exp_f32 v26, v94
  v_exp_f32 v27, v95
  v_add_f32 v13, v24, v25
  v_cvt_pk_bf16_f32 v48, v24, v25
  v_add_f32 v13, v13, v26
  v_exp_f32 v28, v104
  v_exp_f32 v29, v105
  v_cvt_pk_bf16_f32 v49, v26, v27
  v_add_f32 v13, v13, v27
  v_exp_f32 v30, v106
  v_exp_f32 v31, v107
  v_add_f32 v13, v13, v28
  v_cvt_pk_bf16_f32 v50, v28, v29
  v_add_f32 v13, v13, v29
  v_add_f32 v13, v13, v30
  v_cvt_pk_bf16_f32 v51, v30, v31
  v_add_f32 v13, v13, v31
  s_nop 1
  s_setpc_b64 s[76:77]
L_rescale2:
  s_nop 7
  v_max3_f32 v24, v96, v97, v98
  v_max3_f32 v24, v24, v99, v108
  v_max3_f32 v24, v24, v109, v110
  v_max_f32 v24, v24, v111
  v_mov_b32 v30, v24
  v_mov_b32 v31, v24
  s_nop 1
  v_permlane16_swap_b32 v30, v31
  s_nop 1
  v_max_f32 v30, v30, v31
  v_mov_b32 v31, v30
  s_nop 1
  v_permlane32_swap_b32 v30, v31
  s_nop 1
  v_max_f32 v24, v30, v31
  v_max_f32 v24, 0, v24
  v_sub_f32 v25, 0, v24
  v_exp_f32 v25, v25
  v_sub_f32 v40, v40, v24
  v_sub_f32 v41, v41, v24
  v_sub_f32 v42, v42, v24
  v_sub_f32 v43, v43, v24
  v_sub_f32 v96, v96, v24
  v_sub_f32 v97, v97, v24
  v_sub_f32 v98, v98, v24
  v_sub_f32 v99, v99, v24
  v_sub_f32 v108, v108, v24
  v_sub_f32 v109, v109, v24
  v_sub_f32 v110, v110, v24
  v_sub_f32 v111, v111, v24
  v_mul_f32 v11, v11, v25
  v_mul_f32 v168, v168, v25
  v_mul_f32 v169, v169, v25
  v_mul_f32 v170, v170, v25
  v_mul_f32 v171, v171, v25
  v_mul_f32 v180, v180, v25
  v_mul_f32 v181, v181, v25
  v_mul_f32 v182, v182, v25
  v_mul_f32 v183, v183, v25
  v_mul_f32 v192, v192, v25
  v_mul_f32 v193, v193, v25
  v_mul_f32 v194, v194, v25
  v_mul_f32 v195, v195, v25
  v_mul_f32 v204, v204, v25
  v_mul_f32 v205, v205, v25
  v_mul_f32 v206, v206, v25
  v_mul_f32 v207, v207, v25
  v_mul_f32 v216, v216, v25
  v_mul_f32 v217, v217, v25
  v_mul_f32 v218, v218, v25
  v_mul_f32 v219, v219, v25
  v_mul_f32 v228, v228, v25
  v_mul_f32 v229, v229, v25
  v_mul_f32 v230, v230, v25
  v_mul_f32 v231, v231, v25
  v_mul_f32 v240, v240, v25
  v_mul_f32 v241, v241, v25
  v_mul_f32 v242, v242, v25
  v_mul_f32 v243, v243, v25
  v_mul_f32 v252, v252, v25
  v_mul_f32 v253, v253, v25
  v_mul_f32 v254, v254, v25
  v_mul_f32 v255, v255, v25
  v_exp_f32 v24, v96
  v_exp_f32 v25, v97
  v_exp_f32 v26, v98
  v_exp_f32 v27, v99
  v_add_f32 v14, v24, v25
  v_cvt_pk_bf16_f32 v52, v24, v25
  v_add_f32 v14, v14, v26
  v_exp_f32 v28, v108
  v_exp_f32 v29, v109
  v_cvt_pk_bf16_f32 v53, v26, v27
  v_add_f32 v14, v14, v27
  v_exp_f32 v30, v110
  v_exp_f32 v31, v111
  v_add_f32 v14, v14, v28
  v_cvt_pk_bf16_f32 v54, v28, v29
  v_add_f32 v14, v14, v29
  v_add_f32 v14, v14, v30
  v_cvt_pk_bf16_f32 v55, v30, v31
  v_add_f32 v14, v14, v31
  s_nop 1
  s_setpc_b64 s[76:77]
  .fill 3072, 4, 0xBF800000
.section .rodata,"a"
.p2align 6
.amdhsa_kernel standalone__gqa_block_cached__near_ridge_kernel
  .amdhsa_next_free_vgpr 256
  .amdhsa_next_free_sgpr 102
  .amdhsa_accum_offset 256
  .amdhsa_group_segment_fixed_size 0
  .amdhsa_kernarg_size 64
  .amdhsa_user_sgpr_count 2
  .amdhsa_user_sgpr_kernarg_segment_ptr 1
  .amdhsa_system_sgpr_workgroup_id_x 1
  .amdhsa_float_denorm_mode_32 3
.end_amdhsa_kernel
```
